```python
import torch

def _softmax(x, axis=-1):
    return torch.softmax(x, dim=axis)
def _gelu(x):
    return torch.nn.functional.gelu(x, approximate="tanh")
def _silu(x):
    return torch.nn.functional.silu(x)
def _sigmoid(x):
    return torch.sigmoid(x)
def _layernorm(x, axis=-1, eps=1e-5):
    m = x.mean(dim=axis, keepdim=True)
    v = x.var(dim=axis, keepdim=True, unbiased=False)
    return (x - m) / torch.sqrt(v + eps)
def _scatter_add(tgt, idx, src, axis=0):
    return tgt.clone().index_add_(axis, idx, src)
def _segment_sum(src, seg, n):
    out = torch.zeros((n,) + src.shape[1:], dtype=src.dtype)
    return out.index_add_(0, seg, src)
def _pad(x, pw):
    flat = tuple(v for pair in reversed(pw) for v in pair)
    return torch.nn.functional.pad(x, flat)

kernel_name = 'gated_mix__sliding_local_dilated__linear_attn_block__prompt'

def setup_inputs():

    _w = (lambda a: (lambda t: t.to(torch.bfloat16) if t.is_floating_point() else t)(torch.as_tensor(a)))
    def _A_setup():
        B, S, D = 1, 2048, 448
        return {
            "x": _w((lambda *s: torch.randn(*s, dtype=torch.bfloat16) * 0.05)(B, S, D)),
            "wqkv": _w((lambda *s: torch.randn(*s, dtype=torch.bfloat16) * 0.8)(D, 3 * D)),
            "wo": _w((lambda *s: torch.randn(*s, dtype=torch.bfloat16) * 0.05)(D, D)),
        }
    _A_in = _A_setup()

    def _B_setup():
        B, S, D = 1, 2048, 448
        return {
            "x": _w((lambda *s: torch.randn(*s, dtype=torch.bfloat16) * 0.05)(B, S, D)),
            "wqkv": _w((lambda *s: torch.randn(*s, dtype=torch.bfloat16) * 1.6)(D, 3 * D)),
            "wo": _w((lambda *s: torch.randn(*s, dtype=torch.bfloat16) * 0.4)(D, D)),
        }
    _B_in = _B_setup()

    return {
        "A_x": _A_in["x"],
        "A_wqkv": _A_in["wqkv"],
        "A_wo": _A_in["wo"],
        "B_x": _B_in["x"],
        "B_wqkv": _B_in["wqkv"],
        "B_wo": _B_in["wo"],
        "gate_w": _w((lambda *s: torch.randn(*s, dtype=torch.bfloat16) * 0.05)(448) * 16.0),
    }

def reference(A_x, A_wqkv, A_wo, B_x, B_wqkv, B_wo, gate_w):
    def _A_ref(x, wqkv, wo):
        B, S, D = x.shape
        H = 16; Dh = D // H
        W, dil = 8, 2
        qkv = (lambda x, *d: x.permute(*d))((x @ wqkv).reshape(B, S, 3, H, Dh), 2, 0, 3, 1, 4)
        q, k, v = qkv[0], qkv[1], qkv[2]
        scale = Dh ** -0.5
        pos = torch.arange(S)
        off = torch.arange(W) * dil
        idx = pos[:, None] - off[None, :]
        mask = idx >= 0
        idx_c = torch.where(mask, idx, 0).reshape(-1)
        kg = k[:, :, idx_c, :].reshape(B, H, S, W, Dh)
        vg = v[:, :, idx_c, :].reshape(B, H, S, W, Dh)
        logits = torch.einsum("bhsd,bhswd->bhsw", q, kg) * scale
        logits = torch.where(mask[None, None, :, :], logits, -1e9)
        attn = _softmax(logits, axis=-1)
        o = torch.einsum("bhsw,bhswd->bhsd", attn, vg)
        return (lambda x, *d: x.permute(*d))(o, 0, 2, 1, 3).reshape(B, S, D) @ wo

    def _B_ref(x, wqkv, wo):
        B, S, D = x.shape
        H = 16; Dh = D // H
        qkv = (lambda x, *d: x.permute(*d))((x @ wqkv).reshape(B, S, 3, H, Dh), 2, 0, 3, 1, 4)
        q, k, v = qkv[0], qkv[1], qkv[2]
        phi = lambda t: torch.where(t > 0, t + 1, torch.exp(t)) + 1e-6
        pq, pk = phi(q), phi(k)
        kv = torch.einsum("bhsd,bhse->bhde", pk, v)
        z = torch.einsum("bhsd->bhd", pk)
        num = torch.einsum("bhqd,bhde->bhqe", pq, kv)
        den = torch.einsum("bhqd,bhd->bhq", pq, z)[..., None] + 1e-6
        o = num / den
        return (lambda x, *d: x.permute(*d))(o, 0, 2, 1, 3).reshape(B, S, D) @ wo

    x = A_x
    g = _sigmoid((x * gate_w).sum(-1, keepdims=True))
    a = _A_ref(x, A_wqkv, A_wo)
    b = _B_ref(x, B_wqkv, B_wo)
    return g * a + (1 - g) * b
```

```asm
; @launch grid=(256,1,1) block=(512,1,1) lds=163840
.amdgcn_target "amdgcn-amd-amdhsa--gfx950"
.text
.globl gated_mix__sliding_local_dilated__linear_attn_block__prompt_kernel
.p2align 8
.type gated_mix__sliding_local_dilated__linear_attn_block__prompt_kernel,@function
gated_mix__sliding_local_dilated__linear_attn_block__prompt_kernel:
  s_cmp_ge_u32 s2, 0x100
  s_cbranch_scc1 L_end
  s_load_dwordx16 s[36:51], s[0:1], 0
  s_load_dwordx4 s[92:95], s[0:1], 64
  s_getpc_b64 s[90:91]
L_pc:
  v_lshlrev_b32 v3, 7, v0
  v_min_u32 v3, L_end-L_pc, v3
  global_load_dword v135, v3, s[90:91]
  v_and_b32 v1, 63, v0
  v_lshrrev_b32 v2, 6, v0
  s_and_b32 s89, s2, 7
  s_lshr_b32 s78, s2, 3
  v_readfirstlane_b32 s59, v2
  s_and_b32 s56, s89, 1
  s_lshr_b32 s86, s89, 2
  s_lshl_b32 s57, s86, 3
  s_and_b32 s87, s78, 7
  s_add_u32 s57, s57, s87
  s_bfe_u32 s86, s89, 0x10001
  s_lshl_b32 s58, s86, 2
  s_lshr_b32 s88, s78, 3
  s_add_u32 s58, s58, s88
  s_lshl_b32 s88, s88, 1
  s_add_u32 s82, s87, s88
  s_and_b32 s86, s89, 3
  s_add_u32 s82, s82, s86
  s_sub_u32 s86, s82, 7
  s_cmp_ge_u32 s82, 7
  s_cselect_b32 s82, s86, s82
  s_sub_u32 s86, s82, 7
  s_cmp_ge_u32 s82, 7
  s_cselect_b32 s82, s86, s82
  s_and_b32 s61, s59, 1
  s_bfe_u32 s63, s59, 0x10001
  s_lshr_b32 s62, s59, 2
  s_lshl_b32 s71, s82, 7
  s_mul_i32 s64, s71, 1344
  v_lshrrev_b32 v2, 3, v1
  v_lshrrev_b32 v3, 4, v1
  v_and_b32 v8, 7, v1
  s_lshl_b32 s86, s57, 7
  s_lshr_b32 s88, s59, 1
  s_lshl_b32 s87, s88, 5
  s_add_u32 s87, s87, s86
  s_add_u32 s87, s87, s61
  v_lshl_add_u32 v4, v2, 1, s87
  v_mul_u32_u24 v4, 896, v4
  v_xor_b32 v6, v8, v3
  v_lshl_add_u32 v14, v6, 4, v4
  v_xor_b32 v15, 64, v14
  v_add_u32 v15, 14336, v15
  s_mul_i32 s81, s56, 4294938624
  s_add_u32 s81, s81, 86016
  s_lshl_b32 s87, s59, 11
  s_add_u32 s84, s81, s87
  v_mov_b32 v9, 2688
  s_mul_i32 s85, s58, 112
  s_lshl_b32 s86, s59, 6
  s_lshl_b32 s79, s59, 10
  s_lshl_b32 s88, s56, 31
  s_add_u32 s88, s88, 896
  s_add_u32 s88, s88, s85
  s_cmp_eq_u32 s59, 7
  s_cselect_b32 s86, 0, s86
  s_cselect_b32 s87, s88, s85
  s_cselect_b32 s88, s56, 0
  v_add_u32 v4, s86, v1
  v_mul_u32_u24 v5, 9363, v4
  v_lshrrev_b32 v5, 16, v5
  v_mad_i32_i24 v4, v5, -7, v4
  v_bfe_u32 v6, v5, 1, 2
  v_and_b32 v7, 1, v5
  v_lshl_or_b32 v6, v7, 2, v6
  v_and_or_b32 v6, v5, 56, v6
  v_mad_u32_u24 v6, v6, v9, s87
  v_lshl_add_u32 v10, v4, 4, v6
  s_cmp_eq_u32 s88, 1
  s_cselect_b32 s80, 150528, s79
  s_cselect_b32 s60, 0, 1
  s_mul_i32 s82, s56, 896
  s_add_u32 s82, s82, s64
  v_lshlrev_b32 v35, 4, v1
  s_waitcnt lgkmcnt(0)
  s_mov_b32 s4, s36
  s_mov_b32 s5, s37
  s_mov_b32 s6, 1835008
  s_mov_b32 s7, 0x20000
  s_add_u32 m0, s84, 0
  s_nop 0
  buffer_load_dwordx4 v14, s[4:7], s71 offen lds
  s_add_u32 m0, s84, 1024
  s_nop 0
  buffer_load_dwordx4 v15, s[4:7], s71 offen lds
  s_cmp_eq_u32 s56, 0
  s_cselect_b32 s8, s38, s44
  s_cselect_b32 s9, s39, s45
  s_mov_b32 s10, 1204224
  s_mov_b32 s11, 0x20000
  s_mov_b32 m0, s80
  s_nop 0
  buffer_load_dwordx4 v10, s[8:11], s82 offen lds
  s_cmp_lg_u32 s56, 0
  s_cbranch_scc1 L_typeB
  s_add_u32 s86, s59, 1
  s_sub_u32 s87, s59, 6
  s_add_u32 s88, s85, 896
  s_add_u32 s89, s85, 1792
  s_cmp_ge_u32 s59, 6
  s_cselect_b32 s86, s87, s86
  s_cselect_b32 s88, s89, s88
  s_lshl_b32 s86, s86, 6
  v_add_u32 v4, s86, v1
  v_mul_u32_u24 v5, 9363, v4
  v_lshrrev_b32 v5, 16, v5
  v_mad_i32_i24 v4, v5, -7, v4
  v_bfe_u32 v6, v5, 1, 2
  v_and_b32 v7, 1, v5
  v_lshl_or_b32 v6, v7, 2, v6
  v_and_or_b32 v6, v5, 56, v6
  v_mad_u32_u24 v6, v6, v9, s88
  v_lshl_add_u32 v11, v4, 4, v6
  s_add_u32 m0, s79, 8192
  s_nop 0
  buffer_load_dwordx4 v11, s[8:11], s64 offen lds
  s_add_u32 s86, s59, 2
  s_min_u32 s86, s86, 6
  s_lshl_b32 s86, s86, 6
  v_add_u32 v4, s86, v1
  v_mul_u32_u24 v5, 9363, v4
  v_lshrrev_b32 v5, 16, v5
  v_mad_i32_i24 v4, v5, -7, v4
  v_bfe_u32 v6, v5, 1, 2
  v_and_b32 v7, 1, v5
  v_lshl_or_b32 v6, v7, 2, v6
  v_and_or_b32 v6, v5, 56, v6
  v_mad_u32_u24 v6, v6, v9, s89
  v_lshl_add_u32 v12, v4, 4, v6
  s_sub_u32 s87, s59, 5
  s_cmp_ge_u32 s59, 5
  s_cselect_b32 s83, s87, 3
  s_cselect_b32 s60, 0, 1
  s_cselect_b64 s[100:101], -1, 0
  s_cselect_b32 s52, s4, s8
  s_cselect_b32 s53, s5, s9
  s_cselect_b32 s54, s6, s10
  s_mov_b32 s55, 0x20000
  s_and_b32 s87, s83, 2
  s_lshl_b32 s87, s87, 5
  s_and_b32 s88, s83, 1
  s_add_u32 s87, s87, s88
  s_lshl_b32 s86, s57, 7
  s_add_u32 s87, s87, s86
  v_lshl_add_u32 v4, v2, 1, s87
  v_mul_u32_u24 v4, 896, v4
  v_and_b32 v6, 6, v2
  v_xor_b32 v6, v8, v6
  v_lshl_add_u32 v13, v6, 4, v4
  v_add_u32 v13, 0xffffc800, v13
  v_cndmask_b32 v12, v12, v13, s[100:101]
  s_lshl_b32 s83, s83, 10
  s_add_u32 s85, s83, 135168
  s_add_u32 s80, s79, 16384
  s_cmp_eq_u32 s60, 0
  s_cselect_b32 s80, s85, s80
  s_cmp_lg_u32 s59, 4
  s_cbranch_scc1 L_nh1
  s_add_u32 m0, s85, 0
  s_nop 0
  buffer_load_dwordx4 v13, s[4:7], s71 offen lds
L_nh1:
  s_mul_i32 m0, s60, 0
  s_cmp_lg_u32 s60, 0
  s_cselect_b32 s82, s64, s71
  s_add_u32 m0, m0, s80
  s_nop 0
  buffer_load_dwordx4 v12, s[52:55], s82 offen lds
  s_add_u32 s72, s71, 128
  s_cmp_eq_u32 s72, 896
  s_cselect_b32 s72, 0, s72
  s_mul_i32 s65, s72, 1344
  s_add_u32 s73, s72, 128
  s_cmp_eq_u32 s73, 896
  s_cselect_b32 s73, 0, s73
  s_mul_i32 s66, s73, 1344
  s_add_u32 s74, s73, 128
  s_cmp_eq_u32 s74, 896
  s_cselect_b32 s74, 0, s74
  s_mul_i32 s67, s74, 1344
  s_add_u32 s75, s74, 128
  s_cmp_eq_u32 s75, 896
  s_cselect_b32 s75, 0, s75
  s_mul_i32 s68, s75, 1344
  s_add_u32 s76, s75, 128
  s_cmp_eq_u32 s76, 896
  s_cselect_b32 s76, 0, s76
  s_mul_i32 s69, s76, 1344
  s_add_u32 s77, s76, 128
  s_cmp_eq_u32 s77, 896
  s_cselect_b32 s77, 0, s77
  s_mul_i32 s70, s77, 1344
  s_mov_b32 s12, s94
  s_mov_b32 s13, s95
  s_mov_b32 s14, 8388608
  s_mov_b32 s15, 0x20000
  s_mov_b32 s28, s92
  s_mov_b32 s29, s93
  s_mov_b32 s30, 256
  s_mov_b32 s31, 0x20000
  s_mov_b32 s16, s40
  s_mov_b32 s17, s41
  s_mov_b32 s18, 401408
  s_mov_b32 s19, 0x20000
  s_mov_b32 s20, s46
  s_mov_b32 s21, s47
  s_mov_b32 s22, 401408
  s_mov_b32 s23, 0x20000
  s_mov_b32 s24, s50
  s_mov_b32 s25, s51
  s_mov_b32 s26, 1835008
  s_mov_b32 s27, 0x20000
  s_mov_b32 s32, s48
  s_mov_b32 s33, s49
  s_mov_b32 s34, 896
  s_mov_b32 s35, 0x20000
  s_cmp_lg_u32 s59, 4
  s_cbranch_scc1 L_nh2
  s_add_u32 m0, s85, 4096
  s_nop 0
  buffer_load_dwordx4 v13, s[4:7], s72 offen lds
L_nh2:
  s_add_u32 m0, s79, 21504
  s_nop 0
  buffer_load_dwordx4 v10, s[8:11], s65 offen lds
  s_add_u32 m0, s79, 29696
  s_nop 0
  buffer_load_dwordx4 v11, s[8:11], s65 offen lds
  s_mul_i32 m0, s60, 17408
  s_cmp_lg_u32 s60, 0
  s_cselect_b32 s82, s65, s72
  s_add_u32 m0, m0, s80
  s_add_u32 m0, m0, 4096
  s_nop 0
  buffer_load_dwordx4 v12, s[52:55], s82 offen lds
  s_add_u32 m0, s84, 16384
  s_nop 0
  buffer_load_dwordx4 v14, s[4:7], s72 offen lds
  s_add_u32 m0, s84, 17408
  s_nop 0
  buffer_load_dwordx4 v15, s[4:7], s72 offen lds
  s_cmp_ge_u32 s2, 8
  s_cbranch_scc1 L_nozeroA
  v_mov_b32 v104, 0
  v_mov_b32 v105, 0
  v_mov_b32 v106, 0
  v_mov_b32 v107, 0
  v_lshlrev_b32 v4, 4, v0
  s_lshl_b32 s86, s2, 13
  s_add_u32 s86, s86, 4194304
  buffer_store_dwordx4 v[104:107], v4, s[12:15], s86 offen sc1
  s_cmp_lg_u32 s59, 0
  s_cbranch_scc1 L_nozeroA
  s_lshl_b32 s86, s2, 10
  s_add_u32 s86, s86, 4259840
  buffer_store_dwordx4 v[104:107], v4, s[12:15], s86 offen sc1
L_nozeroA:
  v_and_b32 v2, 15, v1
  v_lshrrev_b32 v3, 4, v1
  v_bfe_u32 v4, v1, 2, 2
  v_lshl_add_u32 v4, v3, 2, v4
  v_mul_u32_u24 v4, 224, v4
  v_and_b32 v5, 3, v1
  v_lshl_add_u32 v17, v5, 3, v4
  s_mul_i32 s86, s63, 56
  v_add_u32 v17, s86, v17
  v_lshrrev_b32 v4, 1, v2
  v_xor_b32 v4, v4, v3
  v_lshlrev_b32 v4, 4, v4
  v_lshl_add_u32 v4, v2, 7, v4
  s_and_b32 s86, s59, 5
  s_lshl_b32 s86, s86, 11
  s_add_u32 s86, s86, s81
  v_add_u32 v18, s86, v4
  v_xor_b32 v19, 64, v18
  v_add_u32 v39, 43008, v17
  v_and_b32 v4, 6, v2
  v_xor_b32 v4, v4, v3
  v_lshlrev_b32 v4, 4, v4
  v_and_b32 v5, 7, v2
  v_lshl_add_u32 v4, v5, 7, v4
  s_lshl_b32 s86, s62, 1
  s_add_u32 s86, s86, s61
  s_lshl_b32 s86, s86, 10
  s_add_u32 s86, s86, 135168
  v_add_u32 v20, s86, v4
  v_xor_b32 v21, 64, v20
  s_waitcnt vmcnt(5)
  s_barrier
  ds_read_b128 a[48:51], v18 offset:0
  ds_read_b128 a[52:55], v18 offset:4096
  ds_read_b128 a[56:59], v20 offset:0
  ds_read_b64_tr_b16 a[0:1], v17 offset:0
  ds_read_b64_tr_b16 a[2:3], v17 offset:112
  ds_read_b64_tr_b16 a[4:5], v17 offset:32
  ds_read_b64_tr_b16 a[6:7], v17 offset:144
  ds_read_b64_tr_b16 a[8:9], v17 offset:7168
  ds_read_b64_tr_b16 a[10:11], v17 offset:7280
  ds_read_b64_tr_b16 a[12:13], v17 offset:7200
  ds_read_b64_tr_b16 a[14:15], v17 offset:7312
  ds_read_b64_tr_b16 a[16:17], v17 offset:14336
  ds_read_b64_tr_b16 a[18:19], v17 offset:14448
  ds_read_b64_tr_b16 a[20:21], v17 offset:14368
  ds_read_b64_tr_b16 a[22:23], v17 offset:14480
  ds_read_b128 a[60:63], v19 offset:0
  ds_read_b128 a[64:67], v19 offset:4096
  ds_read_b128 a[68:71], v21 offset:0
  ds_read_b64_tr_b16 a[24:25], v17 offset:3584
  ds_read_b64_tr_b16 a[26:27], v17 offset:3696
  ds_read_b64_tr_b16 a[28:29], v17 offset:3616
  ds_read_b64_tr_b16 a[30:31], v17 offset:3728
  ds_read_b64_tr_b16 a[32:33], v17 offset:10752
  ds_read_b64_tr_b16 a[34:35], v17 offset:10864
  ds_read_b64_tr_b16 a[36:37], v17 offset:10784
  ds_read_b64_tr_b16 a[38:39], v17 offset:10896
  ds_read_b64_tr_b16 a[40:41], v17 offset:17920
  ds_read_b64_tr_b16 a[42:43], v17 offset:18032
  ds_read_b64_tr_b16 a[44:45], v17 offset:17952
  ds_read_b64_tr_b16 a[46:47], v17 offset:18064
  s_waitcnt vmcnt(0)
  s_barrier
  s_waitcnt lgkmcnt(15)
  v_mfma_f32_16x16x32_bf16 v[40:43], a[0:3], a[48:51], 0
  v_mfma_f32_16x16x32_bf16 v[48:51], a[0:3], a[52:55], 0
  ds_read_b64_tr_b16 a[0:1], v17 offset:21504
  ds_read_b64_tr_b16 a[2:3], v17 offset:21616
  s_cmp_lg_u32 s59, 4
  s_cbranch_scc1 L_nh3
  s_add_u32 m0, s85, 8192
  s_nop 0
  buffer_load_dwordx4 v13, s[4:7], s73 offen lds
L_nh3:
  v_mfma_f32_16x16x32_bf16 v[44:47], a[4:7], a[48:51], 0
  v_mfma_f32_16x16x32_bf16 v[52:55], a[4:7], a[52:55], 0
  ds_read_b64_tr_b16 a[4:5], v17 offset:21536
  ds_read_b64_tr_b16 a[6:7], v17 offset:21648
  s_add_u32 m0, s79, 43008
  s_nop 0
  buffer_load_dwordx4 v10, s[8:11], s66 offen lds
  v_mfma_f32_16x16x32_bf16 v[56:59], a[8:11], a[48:51], 0
  v_mfma_f32_16x16x32_bf16 v[64:67], a[8:11], a[52:55], 0
  v_mfma_f32_16x16x32_bf16 v[72:75], a[8:11], a[56:59], 0
  ds_read_b64_tr_b16 a[8:9], v17 offset:28672
  ds_read_b64_tr_b16 a[10:11], v17 offset:28784
  s_add_u32 m0, s79, 51200
  s_nop 0
  buffer_load_dwordx4 v11, s[8:11], s66 offen lds
  v_mfma_f32_16x16x32_bf16 v[60:63], a[12:15], a[48:51], 0
  v_mfma_f32_16x16x32_bf16 v[68:71], a[12:15], a[52:55], 0
  v_mfma_f32_16x16x32_bf16 v[76:79], a[12:15], a[56:59], 0
  ds_read_b64_tr_b16 a[12:13], v17 offset:28704
  ds_read_b64_tr_b16 a[14:15], v17 offset:28816
  s_mul_i32 m0, s60, 34816
  s_cmp_lg_u32 s60, 0
  s_cselect_b32 s82, s66, s73
  s_add_u32 m0, m0, s80
  s_add_u32 m0, m0, 8192
  s_nop 0
  buffer_load_dwordx4 v12, s[52:55], s82 offen lds
  v_mfma_f32_16x16x32_bf16 v[80:83], a[48:51], a[16:19], 0
  v_mfma_f32_16x16x32_bf16 v[88:91], a[52:55], a[16:19], 0
  v_mfma_f32_16x16x32_bf16 v[96:99], a[56:59], a[16:19], 0
  ds_read_b64_tr_b16 a[16:17], v17 offset:35840
  ds_read_b64_tr_b16 a[18:19], v17 offset:35952
  s_add_u32 m0, s84, 32768
  s_nop 0
  buffer_load_dwordx4 v14, s[4:7], s73 offen lds
  v_mfma_f32_16x16x32_bf16 v[84:87], a[48:51], a[20:23], 0
  v_mfma_f32_16x16x32_bf16 v[92:95], a[52:55], a[20:23], 0
  v_mfma_f32_16x16x32_bf16 v[100:103], a[56:59], a[20:23], 0
  ds_read_b64_tr_b16 a[20:21], v17 offset:35872
  ds_read_b64_tr_b16 a[22:23], v17 offset:35984
  s_add_u32 m0, s84, 33792
  s_nop 0
  buffer_load_dwordx4 v15, s[4:7], s73 offen lds
  ds_read_b128 a[48:51], v18 offset:16384
  ds_read_b128 a[52:55], v18 offset:20480
  ds_read_b128 a[56:59], v20 offset:4096
  s_waitcnt lgkmcnt(15)
  v_mfma_f32_16x16x32_bf16 v[40:43], a[24:27], a[60:63], v[40:43]
  v_mov_b32 v7, 0xff800000
  s_or_b32 s88, s57, s62
  v_mfma_f32_16x16x32_bf16 v[48:51], a[24:27], a[64:67], v[48:51]
  v_lshl_add_u32 v4, v3, 2, 0
  v_cmp_le_u32 s[90:91], v4, v2
  ds_read_b64_tr_b16 a[24:25], v17 offset:25088
  ds_read_b64_tr_b16 a[26:27], v17 offset:25200
  s_cmp_lg_u32 s59, 4
  s_cbranch_scc1 L_nh4
  s_add_u32 m0, s85, 12288
  s_nop 0
  buffer_load_dwordx4 v13, s[4:7], s74 offen lds
L_nh4:
  v_mfma_f32_16x16x32_bf16 v[44:47], a[28:31], a[60:63], v[44:47]
  v_sub_u32 v5, v2, v4
  v_and_b32 v5, 15, v5
  v_mfma_f32_16x16x32_bf16 v[52:55], a[28:31], a[64:67], v[52:55]
  v_cmp_gt_u32 vcc, 8, v5
  s_nop 1
  v_cndmask_b32 v22, v7, 0, vcc
  ds_read_b64_tr_b16 a[28:29], v17 offset:25120
  ds_read_b64_tr_b16 a[30:31], v17 offset:25232
  s_add_u32 m0, s79, 64512
  s_nop 0
  buffer_load_dwordx4 v10, s[8:11], s67 offen lds
  v_mfma_f32_16x16x32_bf16 v[56:59], a[32:35], a[60:63], v[56:59]
  s_and_b64 s[100:101], vcc, s[90:91]
  s_cmp_eq_u32 s88, 0
  s_cselect_b64 s[100:101], s[100:101], vcc
  v_cndmask_b32 v26, v7, 0, s[100:101]
  v_mfma_f32_16x16x32_bf16 v[64:67], a[32:35], a[64:67], v[64:67]
  v_lshl_add_u32 v4, v3, 2, 1
  v_cmp_le_u32 s[92:93], v4, v2
  v_mfma_f32_16x16x32_bf16 v[72:75], a[32:35], a[68:71], v[72:75]
  v_sub_u32 v5, v2, v4
  v_and_b32 v5, 15, v5
  ds_read_b64_tr_b16 a[32:33], v17 offset:32256
  ds_read_b64_tr_b16 a[34:35], v17 offset:32368
  s_add_u32 m0, s79, 72704
  s_nop 0
  buffer_load_dwordx4 v11, s[8:11], s67 offen lds
  v_mfma_f32_16x16x32_bf16 v[60:63], a[36:39], a[60:63], v[60:63]
  v_cmp_gt_u32 vcc, 8, v5
  s_nop 1
  v_cndmask_b32 v23, v7, 0, vcc
  v_mfma_f32_16x16x32_bf16 v[68:71], a[36:39], a[64:67], v[68:71]
  s_and_b64 s[100:101], vcc, s[92:93]
  s_cmp_eq_u32 s88, 0
  s_cselect_b64 s[100:101], s[100:101], vcc
  v_cndmask_b32 v27, v7, 0, s[100:101]
  v_mfma_f32_16x16x32_bf16 v[76:79], a[36:39], a[68:71], v[76:79]
  v_lshl_add_u32 v4, v3, 2, 2
  v_cmp_le_u32 s[94:95], v4, v2
  ds_read_b64_tr_b16 a[36:37], v17 offset:32288
  ds_read_b64_tr_b16 a[38:39], v17 offset:32400
  v_mfma_f32_16x16x32_bf16 v[80:83], a[60:63], a[40:43], v[80:83]
  v_sub_u32 v5, v2, v4
  v_and_b32 v5, 15, v5
  v_mfma_f32_16x16x32_bf16 v[88:91], a[64:67], a[40:43], v[88:91]
  v_cmp_gt_u32 vcc, 8, v5
  s_nop 1
  v_cndmask_b32 v24, v7, 0, vcc
  v_mfma_f32_16x16x32_bf16 v[96:99], a[68:71], a[40:43], v[96:99]
  s_and_b64 s[100:101], vcc, s[94:95]
  s_cmp_eq_u32 s88, 0
  s_cselect_b64 s[100:101], s[100:101], vcc
  v_cndmask_b32 v28, v7, 0, s[100:101]
  ds_read_b64_tr_b16 a[40:41], v17 offset:39424
  ds_read_b64_tr_b16 a[42:43], v17 offset:39536
  v_mfma_f32_16x16x32_bf16 v[84:87], a[60:63], a[44:47], v[84:87]
  v_lshl_add_u32 v4, v3, 2, 3
  v_cmp_le_u32 s[96:97], v4, v2
  v_mfma_f32_16x16x32_bf16 v[92:95], a[64:67], a[44:47], v[92:95]
  v_sub_u32 v5, v2, v4
  v_and_b32 v5, 15, v5
  v_mfma_f32_16x16x32_bf16 v[100:103], a[68:71], a[44:47], v[100:103]
  v_cmp_gt_u32 vcc, 8, v5
  s_nop 1
  v_cndmask_b32 v25, v7, 0, vcc
  ds_read_b64_tr_b16 a[44:45], v17 offset:39456
  ds_read_b64_tr_b16 a[46:47], v17 offset:39568
  ds_read_b128 a[60:63], v19 offset:16384
  ds_read_b128 a[64:67], v19 offset:20480
  ds_read_b128 a[68:71], v21 offset:4096
  s_waitcnt vmcnt(2)
  s_barrier
  s_cmp_ge_u32 s2, 8
  s_cbranch_scc1 L_nfA
  s_cmp_lg_u32 s59, 0
  s_cbranch_scc1 L_nfA
  s_lshl_b32 s86, s2, 2
  v_mov_b32 v36, 1
  s_mov_b64 exec, 1
  buffer_store_dword v36, off, s[28:31], s86 sc1
  s_mov_b64 exec, -1
L_nfA:
  s_waitcnt lgkmcnt(15)
  v_mfma_f32_16x16x32_bf16 v[40:43], a[0:3], a[48:51], v[40:43]
  s_and_b64 s[100:101], vcc, s[96:97]
  s_cmp_eq_u32 s88, 0
  s_cselect_b64 s[100:101], s[100:101], vcc
  v_cndmask_b32 v29, v7, 0, s[100:101]
  v_mfma_f32_16x16x32_bf16 v[48:51], a[0:3], a[52:55], v[48:51]
  v_mov_b32 v4, 0xffff
  v_cndmask_b32 v30, 0, v4, s[90:91]
  ds_read_b64_tr_b16 a[0:1], v39 offset:0
  ds_read_b64_tr_b16 a[2:3], v39 offset:112
  s_mul_i32 m0, s60, 52224
  s_cmp_lg_u32 s60, 0
  s_cselect_b32 s82, s67, s74
  s_add_u32 m0, m0, s80
  s_add_u32 m0, m0, 12288
  s_nop 0
  buffer_load_dwordx4 v12, s[52:55], s82 offen lds
  v_mfma_f32_16x16x32_bf16 v[44:47], a[4:7], a[48:51], v[44:47]
  v_mov_b32 v4, 0xffff0000
  v_cndmask_b32 v5, 0, v4, s[92:93]
  v_mfma_f32_16x16x32_bf16 v[52:55], a[4:7], a[52:55], v[52:55]
  v_or_b32 v30, v30, v5
  v_not_b32 v32, v30
  ds_read_b64_tr_b16 a[4:5], v39 offset:32
  ds_read_b64_tr_b16 a[6:7], v39 offset:144
  s_add_u32 m0, s84, 0
  s_nop 0
  buffer_load_dwordx4 v14, s[4:7], s74 offen lds
  v_mfma_f32_16x16x32_bf16 v[56:59], a[8:11], a[48:51], v[56:59]
  v_mov_b32 v4, 0xffff
  v_cndmask_b32 v31, 0, v4, s[94:95]
  v_mfma_f32_16x16x32_bf16 v[64:67], a[8:11], a[52:55], v[64:67]
  v_mov_b32 v4, 0xffff0000
  v_cndmask_b32 v5, 0, v4, s[96:97]
  v_mfma_f32_16x16x32_bf16 v[72:75], a[8:11], a[56:59], v[72:75]
  v_or_b32 v31, v31, v5
  v_not_b32 v33, v31
  ds_read_b64_tr_b16 a[8:9], v39 offset:7168
  ds_read_b64_tr_b16 a[10:11], v39 offset:7280
  s_add_u32 m0, s84, 1024
  s_nop 0
  buffer_load_dwordx4 v15, s[4:7], s74 offen lds
  v_mfma_f32_16x16x32_bf16 v[60:63], a[12:15], a[48:51], v[60:63]
  s_mov_b32 s98, 0x3e8b97f6
  v_cmp_gt_u32 vcc, 3, v3
  v_mfma_f32_16x16x32_bf16 v[68:71], a[12:15], a[52:55], v[68:71]
  s_nop 0
  v_cndmask_b32 v34, 0, -1, vcc
  v_lshrrev_b32 v4, 3, v1
  v_mfma_f32_16x16x32_bf16 v[76:79], a[12:15], a[56:59], v[76:79]
  v_mul_u32_u24 v4, 896, v4
  v_lshlrev_b32 v5, 1, v3
  ds_read_b64_tr_b16 a[12:13], v39 offset:7200
  ds_read_b64_tr_b16 a[14:15], v39 offset:7312
  v_mfma_f32_16x16x32_bf16 v[80:83], a[48:51], a[16:19], v[80:83]
  v_and_b32 v6, 7, v1
  v_xor_b32 v5, v5, v6
  v_mfma_f32_16x16x32_bf16 v[88:91], a[52:55], a[16:19], v[88:91]
  v_lshl_add_u32 v16, v5, 4, v4
  s_lshr_b32 s87, s78, 2
  s_lshl_b32 s87, s87, 7
  s_cmp_ge_u32 s78, 28
  s_cselect_b32 s87, 0x80000000, s87
  v_add_u32 v16, s87, v16
  v_mfma_f32_16x16x32_bf16 v[96:99], a[56:59], a[16:19], v[96:99]
  ds_read_b64_tr_b16 a[16:17], v39 offset:14336
  ds_read_b64_tr_b16 a[18:19], v39 offset:14448
  v_mfma_f32_16x16x32_bf16 v[84:87], a[48:51], a[20:23], v[84:87]
  v_mfma_f32_16x16x32_bf16 v[92:95], a[52:55], a[20:23], v[92:95]
  v_mfma_f32_16x16x32_bf16 v[100:103], a[56:59], a[20:23], v[100:103]
  ds_read_b64_tr_b16 a[20:21], v39 offset:14368
  ds_read_b64_tr_b16 a[22:23], v39 offset:14480
  ds_read_b128 a[48:51], v18 offset:32768
  ds_read_b128 a[52:55], v18 offset:36864
  ds_read_b128 a[56:59], v20 offset:8192
  s_waitcnt lgkmcnt(15)
  v_mfma_f32_16x16x32_bf16 v[40:43], a[24:27], a[60:63], v[40:43]
  v_mfma_f32_16x16x32_bf16 v[48:51], a[24:27], a[64:67], v[48:51]
  ds_read_b64_tr_b16 a[24:25], v39 offset:3584
  ds_read_b64_tr_b16 a[26:27], v39 offset:3696
  s_cmp_lg_u32 s59, 4
  s_cbranch_scc1 L_nh5
  s_add_u32 m0, s85, 0
  s_nop 0
  buffer_load_dwordx4 v13, s[4:7], s75 offen lds
L_nh5:
  v_mfma_f32_16x16x32_bf16 v[44:47], a[28:31], a[60:63], v[44:47]
  v_mfma_f32_16x16x32_bf16 v[52:55], a[28:31], a[64:67], v[52:55]
  ds_read_b64_tr_b16 a[28:29], v39 offset:3616
  ds_read_b64_tr_b16 a[30:31], v39 offset:3728
  s_add_u32 m0, s79, 0
  s_nop 0
  buffer_load_dwordx4 v10, s[8:11], s68 offen lds
  v_mfma_f32_16x16x32_bf16 v[56:59], a[32:35], a[60:63], v[56:59]
  v_mfma_f32_16x16x32_bf16 v[64:67], a[32:35], a[64:67], v[64:67]
  v_mfma_f32_16x16x32_bf16 v[72:75], a[32:35], a[68:71], v[72:75]
  ds_read_b64_tr_b16 a[32:33], v39 offset:10752
  ds_read_b64_tr_b16 a[34:35], v39 offset:10864
  s_add_u32 m0, s79, 8192
  s_nop 0
  buffer_load_dwordx4 v11, s[8:11], s68 offen lds
  v_mfma_f32_16x16x32_bf16 v[60:63], a[36:39], a[60:63], v[60:63]
  v_mfma_f32_16x16x32_bf16 v[68:71], a[36:39], a[64:67], v[68:71]
  v_mfma_f32_16x16x32_bf16 v[76:79], a[36:39], a[68:71], v[76:79]
  ds_read_b64_tr_b16 a[36:37], v39 offset:10784
  ds_read_b64_tr_b16 a[38:39], v39 offset:10896
  v_mfma_f32_16x16x32_bf16 v[80:83], a[60:63], a[40:43], v[80:83]
  v_mfma_f32_16x16x32_bf16 v[88:91], a[64:67], a[40:43], v[88:91]
  v_mfma_f32_16x16x32_bf16 v[96:99], a[68:71], a[40:43], v[96:99]
  ds_read_b64_tr_b16 a[40:41], v39 offset:17920
  ds_read_b64_tr_b16 a[42:43], v39 offset:18032
  v_mfma_f32_16x16x32_bf16 v[84:87], a[60:63], a[44:47], v[84:87]
  v_mfma_f32_16x16x32_bf16 v[92:95], a[64:67], a[44:47], v[92:95]
  v_mfma_f32_16x16x32_bf16 v[100:103], a[68:71], a[44:47], v[100:103]
  ds_read_b64_tr_b16 a[44:45], v39 offset:17952
  ds_read_b64_tr_b16 a[46:47], v39 offset:18064
  ds_read_b128 a[60:63], v19 offset:32768
  ds_read_b128 a[64:67], v19 offset:36864
  ds_read_b128 a[68:71], v21 offset:8192
  s_waitcnt vmcnt(2)
  s_barrier
  s_waitcnt lgkmcnt(15)
  v_mfma_f32_16x16x32_bf16 v[40:43], a[0:3], a[48:51], v[40:43]
  v_mfma_f32_16x16x32_bf16 v[48:51], a[0:3], a[52:55], v[48:51]
  ds_read_b64_tr_b16 a[0:1], v39 offset:21504
  ds_read_b64_tr_b16 a[2:3], v39 offset:21616
  s_mul_i32 m0, s60, 0
  s_cmp_lg_u32 s60, 0
  s_cselect_b32 s82, s68, s75
  s_add_u32 m0, m0, s80
  s_nop 0
  buffer_load_dwordx4 v12, s[52:55], s82 offen lds
  v_mfma_f32_16x16x32_bf16 v[44:47], a[4:7], a[48:51], v[44:47]
  v_mfma_f32_16x16x32_bf16 v[52:55], a[4:7], a[52:55], v[52:55]
  ds_read_b64_tr_b16 a[4:5], v39 offset:21536
  ds_read_b64_tr_b16 a[6:7], v39 offset:21648
  s_add_u32 m0, s84, 16384
  s_nop 0
  buffer_load_dwordx4 v14, s[4:7], s75 offen lds
  v_mfma_f32_16x16x32_bf16 v[56:59], a[8:11], a[48:51], v[56:59]
  v_mfma_f32_16x16x32_bf16 v[64:67], a[8:11], a[52:55], v[64:67]
  v_mfma_f32_16x16x32_bf16 v[72:75], a[8:11], a[56:59], v[72:75]
  ds_read_b64_tr_b16 a[8:9], v39 offset:28672
  ds_read_b64_tr_b16 a[10:11], v39 offset:28784
  s_add_u32 m0, s84, 17408
  s_nop 0
  buffer_load_dwordx4 v15, s[4:7], s75 offen lds
  v_mfma_f32_16x16x32_bf16 v[60:63], a[12:15], a[48:51], v[60:63]
  v_mfma_f32_16x16x32_bf16 v[68:71], a[12:15], a[52:55], v[68:71]
  v_mfma_f32_16x16x32_bf16 v[76:79], a[12:15], a[56:59], v[76:79]
  ds_read_b64_tr_b16 a[12:13], v39 offset:28704
  ds_read_b64_tr_b16 a[14:15], v39 offset:28816
  v_mfma_f32_16x16x32_bf16 v[80:83], a[48:51], a[16:19], v[80:83]
  v_mfma_f32_16x16x32_bf16 v[88:91], a[52:55], a[16:19], v[88:91]
  v_mfma_f32_16x16x32_bf16 v[96:99], a[56:59], a[16:19], v[96:99]
  ds_read_b64_tr_b16 a[16:17], v39 offset:35840
  ds_read_b64_tr_b16 a[18:19], v39 offset:35952
  v_mfma_f32_16x16x32_bf16 v[84:87], a[48:51], a[20:23], v[84:87]
  v_mfma_f32_16x16x32_bf16 v[92:95], a[52:55], a[20:23], v[92:95]
  v_mfma_f32_16x16x32_bf16 v[100:103], a[56:59], a[20:23], v[100:103]
  ds_read_b64_tr_b16 a[20:21], v39 offset:35872
  ds_read_b64_tr_b16 a[22:23], v39 offset:35984
  ds_read_b128 a[48:51], v18 offset:0
  ds_read_b128 a[52:55], v18 offset:4096
  ds_read_b128 a[56:59], v20 offset:12288
  s_waitcnt lgkmcnt(15)
  v_mfma_f32_16x16x32_bf16 v[40:43], a[24:27], a[60:63], v[40:43]
  v_mfma_f32_16x16x32_bf16 v[48:51], a[24:27], a[64:67], v[48:51]
  ds_read_b64_tr_b16 a[24:25], v39 offset:25088
  ds_read_b64_tr_b16 a[26:27], v39 offset:25200
  s_cmp_lg_u32 s59, 4
  s_cbranch_scc1 L_nh6
  s_add_u32 m0, s85, 4096
  s_nop 0
  buffer_load_dwordx4 v13, s[4:7], s76 offen lds
L_nh6:
  v_mfma_f32_16x16x32_bf16 v[44:47], a[28:31], a[60:63], v[44:47]
  v_mfma_f32_16x16x32_bf16 v[52:55], a[28:31], a[64:67], v[52:55]
  ds_read_b64_tr_b16 a[28:29], v39 offset:25120
  ds_read_b64_tr_b16 a[30:31], v39 offset:25232
  s_add_u32 m0, s79, 21504
  s_nop 0
  buffer_load_dwordx4 v10, s[8:11], s69 offen lds
  v_mfma_f32_16x16x32_bf16 v[56:59], a[32:35], a[60:63], v[56:59]
  v_mfma_f32_16x16x32_bf16 v[64:67], a[32:35], a[64:67], v[64:67]
  v_mfma_f32_16x16x32_bf16 v[72:75], a[32:35], a[68:71], v[72:75]
  ds_read_b64_tr_b16 a[32:33], v39 offset:32256
  ds_read_b64_tr_b16 a[34:35], v39 offset:32368
  s_add_u32 m0, s79, 29696
  s_nop 0
  buffer_load_dwordx4 v11, s[8:11], s69 offen lds
  v_mfma_f32_16x16x32_bf16 v[60:63], a[36:39], a[60:63], v[60:63]
  v_mfma_f32_16x16x32_bf16 v[68:71], a[36:39], a[64:67], v[68:71]
  v_mfma_f32_16x16x32_bf16 v[76:79], a[36:39], a[68:71], v[76:79]
  ds_read_b64_tr_b16 a[36:37], v39 offset:32288
  ds_read_b64_tr_b16 a[38:39], v39 offset:32400
  v_mfma_f32_16x16x32_bf16 v[80:83], a[60:63], a[40:43], v[80:83]
  v_mfma_f32_16x16x32_bf16 v[88:91], a[64:67], a[40:43], v[88:91]
  v_mfma_f32_16x16x32_bf16 v[96:99], a[68:71], a[40:43], v[96:99]
  ds_read_b64_tr_b16 a[40:41], v39 offset:39424
  ds_read_b64_tr_b16 a[42:43], v39 offset:39536
  v_mfma_f32_16x16x32_bf16 v[84:87], a[60:63], a[44:47], v[84:87]
  v_mfma_f32_16x16x32_bf16 v[92:95], a[64:67], a[44:47], v[92:95]
  v_mfma_f32_16x16x32_bf16 v[100:103], a[68:71], a[44:47], v[100:103]
  ds_read_b64_tr_b16 a[44:45], v39 offset:39456
  ds_read_b64_tr_b16 a[46:47], v39 offset:39568
  ds_read_b128 a[60:63], v19 offset:0
  ds_read_b128 a[64:67], v19 offset:4096
  ds_read_b128 a[68:71], v21 offset:12288
  v_lshlrev_b32 v37, 2, v1
  s_cmp_lg_u32 s59, 0
  s_cbranch_scc1 L_nlA
  s_mov_b64 exec, 0xff
  buffer_load_dword v36, v37, s[28:31], 0 offen sc1
  s_mov_b64 exec, -1
L_nlA:
  s_waitcnt vmcnt(2)
  s_barrier
  s_waitcnt lgkmcnt(15)
  v_mfma_f32_16x16x32_bf16 v[40:43], a[0:3], a[48:51], v[40:43]
  v_mfma_f32_16x16x32_bf16 v[48:51], a[0:3], a[52:55], v[48:51]
  ds_read_b64_tr_b16 a[0:1], v17 offset:0
  ds_read_b64_tr_b16 a[2:3], v17 offset:112
  s_mul_i32 m0, s60, 17408
  s_cmp_lg_u32 s60, 0
  s_cselect_b32 s82, s69, s76
  s_add_u32 m0, m0, s80
  s_add_u32 m0, m0, 4096
  s_nop 0
  buffer_load_dwordx4 v12, s[52:55], s82 offen lds
  v_mfma_f32_16x16x32_bf16 v[44:47], a[4:7], a[48:51], v[44:47]
  v_mfma_f32_16x16x32_bf16 v[52:55], a[4:7], a[52:55], v[52:55]
  ds_read_b64_tr_b16 a[4:5], v17 offset:32
  ds_read_b64_tr_b16 a[6:7], v17 offset:144
  s_add_u32 m0, s84, 32768
  s_nop 0
  buffer_load_dwordx4 v14, s[4:7], s76 offen lds
  v_mfma_f32_16x16x32_bf16 v[56:59], a[8:11], a[48:51], v[56:59]
  v_mfma_f32_16x16x32_bf16 v[64:67], a[8:11], a[52:55], v[64:67]
  v_mfma_f32_16x16x32_bf16 v[72:75], a[8:11], a[56:59], v[72:75]
  ds_read_b64_tr_b16 a[8:9], v17 offset:7168
  ds_read_b64_tr_b16 a[10:11], v17 offset:7280
  s_add_u32 m0, s84, 33792
  s_nop 0
  buffer_load_dwordx4 v15, s[4:7], s76 offen lds
  v_mfma_f32_16x16x32_bf16 v[60:63], a[12:15], a[48:51], v[60:63]
  v_mfma_f32_16x16x32_bf16 v[68:71], a[12:15], a[52:55], v[68:71]
  v_mfma_f32_16x16x32_bf16 v[76:79], a[12:15], a[56:59], v[76:79]
  ds_read_b64_tr_b16 a[12:13], v17 offset:7200
  ds_read_b64_tr_b16 a[14:15], v17 offset:7312
  v_mfma_f32_16x16x32_bf16 v[80:83], a[48:51], a[16:19], v[80:83]
  v_mfma_f32_16x16x32_bf16 v[88:91], a[52:55], a[16:19], v[88:91]
  v_mfma_f32_16x16x32_bf16 v[96:99], a[56:59], a[16:19], v[96:99]
  ds_read_b64_tr_b16 a[16:17], v17 offset:14336
  ds_read_b64_tr_b16 a[18:19], v17 offset:14448
  v_mfma_f32_16x16x32_bf16 v[84:87], a[48:51], a[20:23], v[84:87]
  v_mfma_f32_16x16x32_bf16 v[92:95], a[52:55], a[20:23], v[92:95]
  v_mfma_f32_16x16x32_bf16 v[100:103], a[56:59], a[20:23], v[100:103]
  ds_read_b64_tr_b16 a[20:21], v17 offset:14368
  ds_read_b64_tr_b16 a[22:23], v17 offset:14480
  ds_read_b128 a[48:51], v18 offset:16384
  ds_read_b128 a[52:55], v18 offset:20480
  ds_read_b128 a[56:59], v20 offset:0
  s_waitcnt lgkmcnt(15)
  v_mfma_f32_16x16x32_bf16 v[40:43], a[24:27], a[60:63], v[40:43]
  v_mfma_f32_16x16x32_bf16 v[48:51], a[24:27], a[64:67], v[48:51]
  ds_read_b64_tr_b16 a[24:25], v17 offset:3584
  ds_read_b64_tr_b16 a[26:27], v17 offset:3696
  s_cmp_lg_u32 s59, 4
  s_cbranch_scc1 L_nh7
  s_add_u32 m0, s85, 8192
  s_nop 0
  buffer_load_dwordx4 v13, s[4:7], s77 offen lds
L_nh7:
  v_mfma_f32_16x16x32_bf16 v[44:47], a[28:31], a[60:63], v[44:47]
  v_mfma_f32_16x16x32_bf16 v[52:55], a[28:31], a[64:67], v[52:55]
  ds_read_b64_tr_b16 a[28:29], v17 offset:3616
  ds_read_b64_tr_b16 a[30:31], v17 offset:3728
  s_add_u32 m0, s79, 43008
  s_nop 0
  buffer_load_dwordx4 v10, s[8:11], s70 offen lds
  v_mfma_f32_16x16x32_bf16 v[56:59], a[32:35], a[60:63], v[56:59]
  v_mfma_f32_16x16x32_bf16 v[64:67], a[32:35], a[64:67], v[64:67]
  v_mfma_f32_16x16x32_bf16 v[72:75], a[32:35], a[68:71], v[72:75]
  ds_read_b64_tr_b16 a[32:33], v17 offset:10752
  ds_read_b64_tr_b16 a[34:35], v17 offset:10864
  s_add_u32 m0, s79, 51200
  s_nop 0
  buffer_load_dwordx4 v11, s[8:11], s70 offen lds
  v_mfma_f32_16x16x32_bf16 v[60:63], a[36:39], a[60:63], v[60:63]
  v_mfma_f32_16x16x32_bf16 v[68:71], a[36:39], a[64:67], v[68:71]
  v_mfma_f32_16x16x32_bf16 v[76:79], a[36:39], a[68:71], v[76:79]
  ds_read_b64_tr_b16 a[36:37], v17 offset:10784
  ds_read_b64_tr_b16 a[38:39], v17 offset:10896
  v_mfma_f32_16x16x32_bf16 v[80:83], a[60:63], a[40:43], v[80:83]
  v_mfma_f32_16x16x32_bf16 v[88:91], a[64:67], a[40:43], v[88:91]
  v_mfma_f32_16x16x32_bf16 v[96:99], a[68:71], a[40:43], v[96:99]
  ds_read_b64_tr_b16 a[40:41], v17 offset:17920
  ds_read_b64_tr_b16 a[42:43], v17 offset:18032
  v_mfma_f32_16x16x32_bf16 v[84:87], a[60:63], a[44:47], v[84:87]
  v_mfma_f32_16x16x32_bf16 v[92:95], a[64:67], a[44:47], v[92:95]
  v_mfma_f32_16x16x32_bf16 v[100:103], a[68:71], a[44:47], v[100:103]
  ds_read_b64_tr_b16 a[44:45], v17 offset:17952
  ds_read_b64_tr_b16 a[46:47], v17 offset:18064
  ds_read_b128 a[60:63], v19 offset:16384
  ds_read_b128 a[64:67], v19 offset:20480
  ds_read_b128 a[68:71], v21 offset:0
  s_waitcnt vmcnt(2)
  s_barrier
  s_waitcnt lgkmcnt(15)
  v_mfma_f32_16x16x32_bf16 v[40:43], a[0:3], a[48:51], v[40:43]
  v_mfma_f32_16x16x32_bf16 v[48:51], a[0:3], a[52:55], v[48:51]
  ds_read_b64_tr_b16 a[0:1], v17 offset:21504
  ds_read_b64_tr_b16 a[2:3], v17 offset:21616
  s_mul_i32 m0, s60, 34816
  s_cmp_lg_u32 s60, 0
  s_cselect_b32 s82, s70, s77
  s_add_u32 m0, m0, s80
  s_add_u32 m0, m0, 8192
  s_nop 0
  buffer_load_dwordx4 v12, s[52:55], s82 offen lds
  v_mfma_f32_16x16x32_bf16 v[44:47], a[4:7], a[48:51], v[44:47]
  v_mfma_f32_16x16x32_bf16 v[52:55], a[4:7], a[52:55], v[52:55]
  ds_read_b64_tr_b16 a[4:5], v17 offset:21536
  ds_read_b64_tr_b16 a[6:7], v17 offset:21648
  s_add_u32 m0, s84, 0
  s_nop 0
  buffer_load_dwordx4 v14, s[4:7], s77 offen lds
  v_mfma_f32_16x16x32_bf16 v[56:59], a[8:11], a[48:51], v[56:59]
  v_mfma_f32_16x16x32_bf16 v[64:67], a[8:11], a[52:55], v[64:67]
  v_mfma_f32_16x16x32_bf16 v[72:75], a[8:11], a[56:59], v[72:75]
  ds_read_b64_tr_b16 a[8:9], v17 offset:28672
  ds_read_b64_tr_b16 a[10:11], v17 offset:28784
  s_add_u32 m0, s84, 1024
  s_nop 0
  buffer_load_dwordx4 v15, s[4:7], s77 offen lds
  v_mfma_f32_16x16x32_bf16 v[60:63], a[12:15], a[48:51], v[60:63]
  v_mfma_f32_16x16x32_bf16 v[68:71], a[12:15], a[52:55], v[68:71]
  v_mfma_f32_16x16x32_bf16 v[76:79], a[12:15], a[56:59], v[76:79]
  ds_read_b64_tr_b16 a[12:13], v17 offset:28704
  ds_read_b64_tr_b16 a[14:15], v17 offset:28816
  v_mfma_f32_16x16x32_bf16 v[80:83], a[48:51], a[16:19], v[80:83]
  v_mfma_f32_16x16x32_bf16 v[88:91], a[52:55], a[16:19], v[88:91]
  v_mfma_f32_16x16x32_bf16 v[96:99], a[56:59], a[16:19], v[96:99]
  ds_read_b64_tr_b16 a[16:17], v17 offset:35840
  ds_read_b64_tr_b16 a[18:19], v17 offset:35952
  v_mfma_f32_16x16x32_bf16 v[84:87], a[48:51], a[20:23], v[84:87]
  v_mfma_f32_16x16x32_bf16 v[92:95], a[52:55], a[20:23], v[92:95]
  v_mfma_f32_16x16x32_bf16 v[100:103], a[56:59], a[20:23], v[100:103]
  ds_read_b64_tr_b16 a[20:21], v17 offset:35872
  ds_read_b64_tr_b16 a[22:23], v17 offset:35984
  ds_read_b128 a[48:51], v18 offset:32768
  ds_read_b128 a[52:55], v18 offset:36864
  ds_read_b128 a[56:59], v20 offset:4096
  s_waitcnt lgkmcnt(15)
  v_mfma_f32_16x16x32_bf16 v[40:43], a[24:27], a[60:63], v[40:43]
  v_mfma_f32_16x16x32_bf16 v[48:51], a[24:27], a[64:67], v[48:51]
  ds_read_b64_tr_b16 a[24:25], v17 offset:25088
  ds_read_b64_tr_b16 a[26:27], v17 offset:25200
  v_mfma_f32_16x16x32_bf16 v[44:47], a[28:31], a[60:63], v[44:47]
  v_mfma_f32_16x16x32_bf16 v[52:55], a[28:31], a[64:67], v[52:55]
  ds_read_b64_tr_b16 a[28:29], v17 offset:25120
  ds_read_b64_tr_b16 a[30:31], v17 offset:25232
  v_mfma_f32_16x16x32_bf16 v[56:59], a[32:35], a[60:63], v[56:59]
  v_mfma_f32_16x16x32_bf16 v[64:67], a[32:35], a[64:67], v[64:67]
  v_mfma_f32_16x16x32_bf16 v[72:75], a[32:35], a[68:71], v[72:75]
  ds_read_b64_tr_b16 a[32:33], v17 offset:32256
  ds_read_b64_tr_b16 a[34:35], v17 offset:32368
  v_mfma_f32_16x16x32_bf16 v[60:63], a[36:39], a[60:63], v[60:63]
  v_mfma_f32_16x16x32_bf16 v[68:71], a[36:39], a[64:67], v[68:71]
  v_mfma_f32_16x16x32_bf16 v[76:79], a[36:39], a[68:71], v[76:79]
  ds_read_b64_tr_b16 a[36:37], v17 offset:32288
  ds_read_b64_tr_b16 a[38:39], v17 offset:32400
  v_mfma_f32_16x16x32_bf16 v[80:83], a[60:63], a[40:43], v[80:83]
  v_mfma_f32_16x16x32_bf16 v[88:91], a[64:67], a[40:43], v[88:91]
  v_mfma_f32_16x16x32_bf16 v[96:99], a[68:71], a[40:43], v[96:99]
  ds_read_b64_tr_b16 a[40:41], v17 offset:39424
  ds_read_b64_tr_b16 a[42:43], v17 offset:39536
  v_mfma_f32_16x16x32_bf16 v[84:87], a[60:63], a[44:47], v[84:87]
  v_mfma_f32_16x16x32_bf16 v[92:95], a[64:67], a[44:47], v[92:95]
  v_mfma_f32_16x16x32_bf16 v[100:103], a[68:71], a[44:47], v[100:103]
  ds_read_b64_tr_b16 a[44:45], v17 offset:39456
  ds_read_b64_tr_b16 a[46:47], v17 offset:39568
  ds_read_b128 a[60:63], v19 offset:32768
  ds_read_b128 a[64:67], v19 offset:36864
  ds_read_b128 a[68:71], v21 offset:4096
  s_waitcnt vmcnt(0)
  s_barrier
  s_waitcnt lgkmcnt(15)
  v_mfma_f32_16x16x32_bf16 v[40:43], a[0:3], a[48:51], v[40:43]
  v_mfma_f32_16x16x32_bf16 v[48:51], a[0:3], a[52:55], v[48:51]
  ds_read_b64_tr_b16 a[0:1], v39 offset:0
  ds_read_b64_tr_b16 a[2:3], v39 offset:112
  v_mfma_f32_16x16x32_bf16 v[44:47], a[4:7], a[48:51], v[44:47]
  v_mfma_f32_16x16x32_bf16 v[52:55], a[4:7], a[52:55], v[52:55]
  ds_read_b64_tr_b16 a[4:5], v39 offset:32
  ds_read_b64_tr_b16 a[6:7], v39 offset:144
  v_mfma_f32_16x16x32_bf16 v[56:59], a[8:11], a[48:51], v[56:59]
  v_mfma_f32_16x16x32_bf16 v[64:67], a[8:11], a[52:55], v[64:67]
  v_mfma_f32_16x16x32_bf16 v[72:75], a[8:11], a[56:59], v[72:75]
  ds_read_b64_tr_b16 a[8:9], v39 offset:7168
  ds_read_b64_tr_b16 a[10:11], v39 offset:7280
  v_mfma_f32_16x16x32_bf16 v[60:63], a[12:15], a[48:51], v[60:63]
  v_mfma_f32_16x16x32_bf16 v[68:71], a[12:15], a[52:55], v[68:71]
  v_mfma_f32_16x16x32_bf16 v[76:79], a[12:15], a[56:59], v[76:79]
  ds_read_b64_tr_b16 a[12:13], v39 offset:7200
  ds_read_b64_tr_b16 a[14:15], v39 offset:7312
  v_mfma_f32_16x16x32_bf16 v[80:83], a[48:51], a[16:19], v[80:83]
  v_mfma_f32_16x16x32_bf16 v[88:91], a[52:55], a[16:19], v[88:91]
  v_mfma_f32_16x16x32_bf16 v[96:99], a[56:59], a[16:19], v[96:99]
  ds_read_b64_tr_b16 a[16:17], v39 offset:14336
  ds_read_b64_tr_b16 a[18:19], v39 offset:14448
  v_mfma_f32_16x16x32_bf16 v[84:87], a[48:51], a[20:23], v[84:87]
  v_mfma_f32_16x16x32_bf16 v[92:95], a[52:55], a[20:23], v[92:95]
  v_mfma_f32_16x16x32_bf16 v[100:103], a[56:59], a[20:23], v[100:103]
  ds_read_b64_tr_b16 a[20:21], v39 offset:14368
  ds_read_b64_tr_b16 a[22:23], v39 offset:14480
  ds_read_b128 a[48:51], v18 offset:0
  ds_read_b128 a[52:55], v18 offset:4096
  ds_read_b128 a[56:59], v20 offset:8192
  s_waitcnt lgkmcnt(15)
  v_mfma_f32_16x16x32_bf16 v[40:43], a[24:27], a[60:63], v[40:43]
  v_mfma_f32_16x16x32_bf16 v[48:51], a[24:27], a[64:67], v[48:51]
  ds_read_b64_tr_b16 a[24:25], v39 offset:3584
  ds_read_b64_tr_b16 a[26:27], v39 offset:3696
  v_mfma_f32_16x16x32_bf16 v[44:47], a[28:31], a[60:63], v[44:47]
  v_mfma_f32_16x16x32_bf16 v[52:55], a[28:31], a[64:67], v[52:55]
  ds_read_b64_tr_b16 a[28:29], v39 offset:3616
  ds_read_b64_tr_b16 a[30:31], v39 offset:3728
  v_mfma_f32_16x16x32_bf16 v[56:59], a[32:35], a[60:63], v[56:59]
  v_mfma_f32_16x16x32_bf16 v[64:67], a[32:35], a[64:67], v[64:67]
  v_mfma_f32_16x16x32_bf16 v[72:75], a[32:35], a[68:71], v[72:75]
  ds_read_b64_tr_b16 a[32:33], v39 offset:10752
  ds_read_b64_tr_b16 a[34:35], v39 offset:10864
  v_mfma_f32_16x16x32_bf16 v[60:63], a[36:39], a[60:63], v[60:63]
  v_mfma_f32_16x16x32_bf16 v[68:71], a[36:39], a[64:67], v[68:71]
  v_mfma_f32_16x16x32_bf16 v[76:79], a[36:39], a[68:71], v[76:79]
  ds_read_b64_tr_b16 a[36:37], v39 offset:10784
  ds_read_b64_tr_b16 a[38:39], v39 offset:10896
  v_mfma_f32_16x16x32_bf16 v[80:83], a[60:63], a[40:43], v[80:83]
  v_mfma_f32_16x16x32_bf16 v[88:91], a[64:67], a[40:43], v[88:91]
  v_mfma_f32_16x16x32_bf16 v[96:99], a[68:71], a[40:43], v[96:99]
  ds_read_b64_tr_b16 a[40:41], v39 offset:17920
  ds_read_b64_tr_b16 a[42:43], v39 offset:18032
  v_mfma_f32_16x16x32_bf16 v[84:87], a[60:63], a[44:47], v[84:87]
  v_mfma_f32_16x16x32_bf16 v[92:95], a[64:67], a[44:47], v[92:95]
  v_mfma_f32_16x16x32_bf16 v[100:103], a[68:71], a[44:47], v[100:103]
  ds_read_b64_tr_b16 a[44:45], v39 offset:17952
  ds_read_b64_tr_b16 a[46:47], v39 offset:18064
  ds_read_b128 a[60:63], v19 offset:0
  ds_read_b128 a[64:67], v19 offset:4096
  ds_read_b128 a[68:71], v21 offset:8192
  s_waitcnt lgkmcnt(15)
  v_mfma_f32_16x16x32_bf16 v[40:43], a[0:3], a[48:51], v[40:43]
  v_mfma_f32_16x16x32_bf16 v[48:51], a[0:3], a[52:55], v[48:51]
  v_mfma_f32_16x16x32_bf16 v[44:47], a[4:7], a[48:51], v[44:47]
  v_mfma_f32_16x16x32_bf16 v[52:55], a[4:7], a[52:55], v[52:55]
  v_mfma_f32_16x16x32_bf16 v[56:59], a[8:11], a[48:51], v[56:59]
  v_mfma_f32_16x16x32_bf16 v[64:67], a[8:11], a[52:55], v[64:67]
  v_mfma_f32_16x16x32_bf16 v[72:75], a[8:11], a[56:59], v[72:75]
  v_mfma_f32_16x16x32_bf16 v[60:63], a[12:15], a[48:51], v[60:63]
  v_mfma_f32_16x16x32_bf16 v[68:71], a[12:15], a[52:55], v[68:71]
  v_mfma_f32_16x16x32_bf16 v[76:79], a[12:15], a[56:59], v[76:79]
  v_mfma_f32_16x16x32_bf16 v[80:83], a[48:51], a[16:19], v[80:83]
  v_mfma_f32_16x16x32_bf16 v[88:91], a[52:55], a[16:19], v[88:91]
  v_mfma_f32_16x16x32_bf16 v[96:99], a[56:59], a[16:19], v[96:99]
  v_mfma_f32_16x16x32_bf16 v[84:87], a[48:51], a[20:23], v[84:87]
  v_mfma_f32_16x16x32_bf16 v[92:95], a[52:55], a[20:23], v[92:95]
  v_mfma_f32_16x16x32_bf16 v[100:103], a[56:59], a[20:23], v[100:103]
  s_waitcnt lgkmcnt(0)
  v_mfma_f32_16x16x32_bf16 v[40:43], a[24:27], a[60:63], v[40:43]
  v_mfma_f32_16x16x32_bf16 v[48:51], a[24:27], a[64:67], v[48:51]
  v_mfma_f32_16x16x32_bf16 v[44:47], a[28:31], a[60:63], v[44:47]
  v_mfma_f32_16x16x32_bf16 v[52:55], a[28:31], a[64:67], v[52:55]
  v_mfma_f32_16x16x32_bf16 v[56:59], a[32:35], a[60:63], v[56:59]
  v_mfma_f32_16x16x32_bf16 v[64:67], a[32:35], a[64:67], v[64:67]
  v_mfma_f32_16x16x32_bf16 v[72:75], a[32:35], a[68:71], v[72:75]
  v_mfma_f32_16x16x32_bf16 v[60:63], a[36:39], a[60:63], v[60:63]
  v_mfma_f32_16x16x32_bf16 v[68:71], a[36:39], a[64:67], v[68:71]
  v_mfma_f32_16x16x32_bf16 v[76:79], a[36:39], a[68:71], v[76:79]
  v_mfma_f32_16x16x32_bf16 v[80:83], a[60:63], a[40:43], v[80:83]
  v_mfma_f32_16x16x32_bf16 v[88:91], a[64:67], a[40:43], v[88:91]
  v_mfma_f32_16x16x32_bf16 v[96:99], a[68:71], a[40:43], v[96:99]
  v_mfma_f32_16x16x32_bf16 v[84:87], a[60:63], a[44:47], v[84:87]
  v_mfma_f32_16x16x32_bf16 v[92:95], a[64:67], a[44:47], v[92:95]
  v_mfma_f32_16x16x32_bf16 v[100:103], a[68:71], a[44:47], v[100:103]
  s_cmp_lg_u32 s59, 0
  s_cbranch_scc1 L_ncA
  s_mov_b64 exec, 0xff
  s_mov_b32 s3, 0
L_fcA:
  v_cmp_eq_u32 vcc, 0, v36
  s_nop 3
  s_cbranch_vccz L_fokA
  s_add_u32 s3, s3, 1
  s_cmp_ge_u32 s3, 524288
  s_cbranch_scc1 L_fokA
  s_sleep 2
  buffer_load_dword v36, v37, s[28:31], 0 offen sc1
  s_waitcnt vmcnt(0)
  s_branch L_fcA
L_fokA:
  s_mov_b64 exec, -1
L_ncA:
  s_and_b32 s86, s78, 3
  s_lshl_b32 s86, s86, 4
  s_add_u32 s86, s86, s59
  s_lshl_b32 s85, s86, 10
  s_mul_i32 s84, s85, 7
  s_barrier
  v_cvt_pk_bf16_f32 v104, v56, v57
  s_add_u32 m0, s85, 57344
  s_nop 0
  buffer_load_dwordx4 v16, s[20:23], s84 offen lds
  s_add_u32 s85, s85, 8192
  s_cmp_ge_u32 s85, 57344
  s_cselect_b32 s83, 57344, 0
  s_sub_u32 s85, s85, s83
  s_mul_i32 s84, s85, 7
  v_cvt_pk_bf16_f32 v105, v58, v59
  v_cvt_pk_bf16_f32 v106, v60, v61
  v_cvt_pk_bf16_f32 v107, v62, v63
  v_and_b32 v106, v34, v106
  v_and_b32 v107, v34, v107
  v_cvt_pk_bf16_f32 v112, v72, v73
  s_add_u32 m0, s85, 57344
  s_nop 0
  buffer_load_dwordx4 v16, s[20:23], s84 offen lds
  s_add_u32 s85, s85, 8192
  s_cmp_ge_u32 s85, 57344
  s_cselect_b32 s83, 57344, 0
  s_sub_u32 s85, s85, s83
  s_mul_i32 s84, s85, 7
  v_cvt_pk_bf16_f32 v113, v74, v75
  v_cvt_pk_bf16_f32 v114, v76, v77
  v_cvt_pk_bf16_f32 v115, v78, v79
  v_and_b32 v114, v34, v114
  v_and_b32 v115, v34, v115
  v_cvt_pk_bf16_f32 v108, v64, v65
  s_add_u32 m0, s85, 57344
  s_nop 0
  buffer_load_dwordx4 v16, s[20:23], s84 offen lds
  s_add_u32 s85, s85, 8192
  s_cmp_ge_u32 s85, 57344
  s_cselect_b32 s83, 57344, 0
  s_sub_u32 s85, s85, s83
  s_mul_i32 s84, s85, 7
  v_cvt_pk_bf16_f32 v109, v66, v67
  v_cvt_pk_bf16_f32 v110, v68, v69
  v_cvt_pk_bf16_f32 v111, v70, v71
  v_and_b32 v110, v34, v110
  v_and_b32 v111, v34, v111
  v_cvt_pk_bf16_f32 v116, v40, v41
  s_add_u32 m0, s85, 57344
  s_nop 0
  buffer_load_dwordx4 v16, s[20:23], s84 offen lds
  s_add_u32 s85, s85, 8192
  s_cmp_ge_u32 s85, 57344
  s_cselect_b32 s83, 57344, 0
  s_sub_u32 s85, s85, s83
  s_mul_i32 s84, s85, 7
  v_cvt_pk_bf16_f32 v117, v42, v43
  v_cvt_pk_bf16_f32 v118, v44, v45
  v_cvt_pk_bf16_f32 v119, v46, v47
  v_and_b32 v118, v34, v118
  v_and_b32 v119, v34, v119
  v_cvt_pk_bf16_f32 v120, v48, v49
  s_add_u32 m0, s85, 57344
  s_nop 0
  buffer_load_dwordx4 v16, s[20:23], s84 offen lds
  s_add_u32 s85, s85, 8192
  s_cmp_ge_u32 s85, 57344
  s_cselect_b32 s83, 57344, 0
  s_sub_u32 s85, s85, s83
  s_mul_i32 s84, s85, 7
  v_cvt_pk_bf16_f32 v121, v50, v51
  v_cvt_pk_bf16_f32 v122, v52, v53
  v_cvt_pk_bf16_f32 v123, v54, v55
  v_and_b32 v122, v34, v122
  v_and_b32 v123, v34, v123
  v_mfma_f32_16x16x32_bf16 v[40:43], v[104:107], v[116:119], 0
  s_add_u32 m0, s85, 57344
  s_nop 0
  buffer_load_dwordx4 v16, s[20:23], s84 offen lds
  s_add_u32 s85, s85, 8192
  s_cmp_ge_u32 s85, 57344
  s_cselect_b32 s83, 57344, 0
  s_sub_u32 s85, s85, s83
  s_mul_i32 s84, s85, 7
  v_mfma_f32_16x16x32_bf16 v[44:47], v[112:115], v[116:119], 0
  v_mfma_f32_16x16x32_bf16 v[48:51], v[108:111], v[120:123], 0
  v_mfma_f32_16x16x32_bf16 v[52:55], v[104:107], v[120:123], 0
  v_cvt_pk_bf16_f32 v124, v96, v97
  v_cvt_pk_bf16_f32 v125, v98, v99
  v_cvt_pk_bf16_f32 v126, v80, v81
  s_add_u32 m0, s85, 57344
  s_nop 0
  buffer_load_dwordx4 v16, s[20:23], s84 offen lds
  s_add_u32 s85, s85, 8192
  s_cmp_ge_u32 s85, 57344
  s_cselect_b32 s83, 57344, 0
  s_sub_u32 s85, s85, s83
  s_mul_i32 s84, s85, 7
  v_cvt_pk_bf16_f32 v127, v82, v83
  v_cvt_pk_bf16_f32 v128, v88, v89
  v_cvt_pk_bf16_f32 v129, v90, v91
  v_cvt_pk_bf16_f32 v130, v100, v101
  v_cvt_pk_bf16_f32 v131, v102, v103
  v_cvt_pk_bf16_f32 v132, v84, v85
  v_cvt_pk_bf16_f32 v133, v86, v87
  v_cvt_pk_bf16_f32 v134, v92, v93
  v_cvt_pk_bf16_f32 v135, v94, v95
  v_cndmask_b32 v40, v44, v40, s[90:91]
  v_cndmask_b32 v48, v52, v48, s[90:91]
  v_cndmask_b32 v41, v45, v41, s[92:93]
  v_cndmask_b32 v49, v53, v49, s[92:93]
  v_cndmask_b32 v42, v46, v42, s[94:95]
  v_cndmask_b32 v50, v54, v50, s[94:95]
  v_cndmask_b32 v43, v47, v43, s[96:97]
  v_cndmask_b32 v51, v55, v51, s[96:97]
  v_fma_f32 v40, v40, s98, v26
  v_fma_f32 v48, v48, s98, v22
  v_fma_f32 v41, v41, s98, v27
  v_fma_f32 v49, v49, s98, v23
  v_fma_f32 v42, v42, s98, v28
  v_fma_f32 v50, v50, s98, v24
  v_fma_f32 v43, v43, s98, v29
  v_fma_f32 v51, v51, s98, v25
  v_max3_f32 v68, v40, v41, v42
  v_max3_f32 v72, v48, v49, v50
  v_max_f32 v68, v68, v43
  v_max_f32 v72, v72, v51
  v_mov_b32 v69, v68
  v_mov_b32 v73, v72
  s_nop 0
  v_permlane16_swap_b32 v68, v69
  v_permlane16_swap_b32 v72, v73
  v_max_f32 v68, v68, v69
  v_max_f32 v72, v72, v73
  v_mov_b32 v69, v68
  v_mov_b32 v73, v72
  s_nop 0
  v_permlane32_swap_b32 v68, v69
  v_permlane32_swap_b32 v72, v73
  v_max_f32 v68, v68, v69
  v_max_f32 v72, v72, v73
  v_sub_f32 v40, v40, v68
  v_sub_f32 v48, v48, v72
  v_sub_f32 v41, v41, v68
  v_sub_f32 v49, v49, v72
  v_sub_f32 v42, v42, v68
  v_sub_f32 v50, v50, v72
  v_sub_f32 v43, v43, v68
  v_sub_f32 v51, v51, v72
  v_exp_f32 v40, v40
  v_exp_f32 v48, v48
  v_exp_f32 v41, v41
  v_exp_f32 v49, v49
  v_exp_f32 v42, v42
  v_exp_f32 v50, v50
  v_exp_f32 v43, v43
  v_exp_f32 v51, v51
  v_add_f32 v68, v40, v41
  v_add_f32 v72, v48, v49
  v_add_f32 v69, v42, v43
  v_add_f32 v73, v50, v51
  v_cvt_pk_bf16_f32 v70, v40, v41
  v_cvt_pk_bf16_f32 v74, v48, v49
  v_add_f32 v68, v68, v69
  v_add_f32 v72, v72, v73
  v_cvt_pk_bf16_f32 v71, v42, v43
  v_cvt_pk_bf16_f32 v75, v50, v51
  v_mov_b32 v69, v68
  v_mov_b32 v73, v72
  s_nop 0
  v_permlane16_swap_b32 v68, v69
  v_permlane16_swap_b32 v72, v73
  v_add_f32 v68, v68, v69
  v_add_f32 v72, v72, v73
  v_mov_b32 v69, v68
  v_mov_b32 v73, v72
  s_nop 0
  v_permlane32_swap_b32 v68, v69
  v_permlane32_swap_b32 v72, v73
  v_add_f32 v68, v68, v69
  v_add_f32 v72, v72, v73
  v_and_b32 v56, v32, v70
  v_and_b32 v60, v32, v74
  v_and_b32 v57, v33, v71
  v_and_b32 v61, v33, v75
  v_and_b32 v58, v30, v70
  v_and_b32 v62, v30, v74
  v_and_b32 v59, v31, v71
  v_and_b32 v63, v31, v75
  v_rcp_f32 v64, v68
  v_rcp_f32 v65, v72
  v_mfma_f32_16x16x32_bf16 v[80:83], v[124:127], v[56:59], 0
  v_mfma_f32_16x16x32_bf16 v[84:87], v[130:133], v[56:59], 0
  v_mfma_f32_16x16x32_bf16 v[88:91], v[126:129], v[60:63], 0
  v_mfma_f32_16x16x32_bf16 v[92:95], v[132:135], v[60:63], 0
  s_lshl_b32 s86, s57, 3
  s_and_b32 s87, s59, 5
  s_add_u32 s86, s86, s87
  s_lshl_b32 s86, s86, 5
  s_lshl_b32 s87, s56, 4
  s_add_u32 s86, s86, s87
  s_lshl_b32 s87, s58, 1
  s_add_u32 s86, s86, s87
  s_add_u32 s86, s86, s63
  s_lshl_b32 s94, s86, 10
  s_add_u32 s95, s94, 65536
  v_mul_f32 v80, v64, v80
  v_mul_f32 v81, v64, v81
  v_mul_f32 v82, v64, v82
  v_mul_f32 v83, v64, v83
  v_cvt_pk_bf16_f32 v96, v80, v81
  v_cvt_pk_bf16_f32 v97, v82, v83
  v_mul_f32 v84, v64, v84
  v_mul_f32 v85, v64, v85
  v_mul_f32 v86, v64, v86
  v_mul_f32 v87, v64, v87
  v_cvt_pk_bf16_f32 v98, v84, v85
  v_cvt_pk_bf16_f32 v99, v86, v87
  v_and_b32 v98, v34, v98
  v_and_b32 v99, v34, v99
  buffer_store_dwordx4 v[96:99], v35, s[12:15], s94 offen sc1
  v_mul_f32 v88, v65, v88
  v_mul_f32 v89, v65, v89
  v_mul_f32 v90, v65, v90
  v_mul_f32 v91, v65, v91
  v_cvt_pk_bf16_f32 v100, v88, v89
  v_cvt_pk_bf16_f32 v101, v90, v91
  v_mul_f32 v92, v65, v92
  v_mul_f32 v93, v65, v93
  v_mul_f32 v94, v65, v94
  v_mul_f32 v95, v65, v95
  v_cvt_pk_bf16_f32 v102, v92, v93
  v_cvt_pk_bf16_f32 v103, v94, v95
  v_and_b32 v102, v34, v102
  v_and_b32 v103, v34, v103
  buffer_store_dwordx4 v[100:103], v35, s[12:15], s95 offen sc1
  s_branch L_publish
L_typeB:
  s_add_u32 s72, s71, 128
  s_cmp_eq_u32 s72, 896
  s_cselect_b32 s72, 0, s72
  s_mul_i32 s65, s72, 1344
  s_add_u32 s73, s72, 128
  s_cmp_eq_u32 s73, 896
  s_cselect_b32 s73, 0, s73
  s_mul_i32 s66, s73, 1344
  s_add_u32 s74, s73, 128
  s_cmp_eq_u32 s74, 896
  s_cselect_b32 s74, 0, s74
  s_mul_i32 s67, s74, 1344
  s_add_u32 s75, s74, 128
  s_cmp_eq_u32 s75, 896
  s_cselect_b32 s75, 0, s75
  s_mul_i32 s68, s75, 1344
  s_add_u32 s76, s75, 128
  s_cmp_eq_u32 s76, 896
  s_cselect_b32 s76, 0, s76
  s_mul_i32 s69, s76, 1344
  s_add_u32 s77, s76, 128
  s_cmp_eq_u32 s77, 896
  s_cselect_b32 s77, 0, s77
  s_mul_i32 s70, s77, 1344
  s_mov_b32 s12, s94
  s_mov_b32 s13, s95
  s_mov_b32 s14, 8388608
  s_mov_b32 s15, 0x20000
  s_mov_b32 s28, s92
  s_mov_b32 s29, s93
  s_mov_b32 s30, 256
  s_mov_b32 s31, 0x20000
  s_mov_b32 s16, s40
  s_mov_b32 s17, s41
  s_mov_b32 s18, 401408
  s_mov_b32 s19, 0x20000
  s_mov_b32 s20, s46
  s_mov_b32 s21, s47
  s_mov_b32 s22, 401408
  s_mov_b32 s23, 0x20000
  s_mov_b32 s24, s50
  s_mov_b32 s25, s51
  s_mov_b32 s26, 1835008
  s_mov_b32 s27, 0x20000
  s_mov_b32 s32, s48
  s_mov_b32 s33, s49
  s_mov_b32 s34, 896
  s_mov_b32 s35, 0x20000
  s_mul_i32 m0, s60, 7168
  s_add_u32 s82, s65, 896
  s_add_u32 m0, m0, s80
  s_nop 0
  buffer_load_dwordx4 v10, s[8:11], s82 offen lds
  s_add_u32 m0, s84, 16384
  s_nop 0
  buffer_load_dwordx4 v14, s[4:7], s72 offen lds
  s_add_u32 m0, s84, 17408
  s_nop 0
  buffer_load_dwordx4 v15, s[4:7], s72 offen lds
  s_cmp_ge_u32 s2, 8
  s_cbranch_scc1 L_nozeroB
  v_mov_b32 v104, 0
  v_mov_b32 v105, 0
  v_mov_b32 v106, 0
  v_mov_b32 v107, 0
  v_lshlrev_b32 v4, 4, v0
  s_lshl_b32 s86, s2, 13
  s_add_u32 s86, s86, 4194304
  buffer_store_dwordx4 v[104:107], v4, s[12:15], s86 offen sc1
  s_cmp_lg_u32 s59, 0
  s_cbranch_scc1 L_nozeroB
  s_lshl_b32 s86, s2, 10
  s_add_u32 s86, s86, 4259840
  buffer_store_dwordx4 v[104:107], v4, s[12:15], s86 offen sc1
L_nozeroB:
  s_cmp_lg_u32 s59, 0
  s_cbranch_scc1 L_nogw
  s_mov_b32 exec_hi, 0xffffff
  s_mov_b32 m0, 159744
  s_nop 0
  buffer_load_dwordx4 v35, s[32:35], 0 offen lds
  s_mov_b32 m0, 160640
  s_nop 0
  buffer_load_dwordx4 v35, s[32:35], 0 offen lds
  s_mov_b64 exec, -1
L_nogw:
  v_and_b32 v2, 15, v1
  v_lshrrev_b32 v3, 4, v1
  v_bfe_u32 v4, v1, 2, 2
  v_lshl_add_u32 v4, v3, 2, v4
  v_mul_u32_u24 v4, 224, v4
  v_and_b32 v5, 3, v1
  v_lshl_add_u32 v17, v5, 3, v4
  s_mul_i32 s86, s63, 56
  v_add_u32 v17, s86, v17
  v_lshrrev_b32 v4, 1, v2
  v_xor_b32 v4, v4, v3
  v_lshlrev_b32 v4, 4, v4
  v_lshl_add_u32 v4, v2, 7, v4
  s_and_b32 s86, s59, 5
  s_lshl_b32 s86, s86, 11
  s_add_u32 s86, s86, s81
  v_add_u32 v18, s86, v4
  v_xor_b32 v19, 64, v18
  s_waitcnt vmcnt(3)
  s_barrier
  ds_read_b128 a[0:3], v18 offset:0
  ds_read_b128 a[56:59], v18 offset:4096
  ds_read_b64_tr_b16 v[40:41], v17 offset:0
  ds_read_b64_tr_b16 v[42:43], v17 offset:112
  ds_read_b64_tr_b16 v[44:45], v17 offset:32
  ds_read_b64_tr_b16 v[46:47], v17 offset:144
  ds_read_b128 a[4:7], v19 offset:0
  ds_read_b128 a[60:63], v19 offset:4096
  ds_read_b64_tr_b16 v[48:49], v17 offset:3584
  ds_read_b64_tr_b16 v[50:51], v17 offset:3696
  ds_read_b64_tr_b16 v[52:53], v17 offset:3616
  ds_read_b64_tr_b16 v[54:55], v17 offset:3728
  s_waitcnt vmcnt(0)
  s_barrier
  s_waitcnt lgkmcnt(10)
  s_waitcnt lgkmcnt(8)
  v_mfma_f32_16x16x32_bf16 v[56:59], a[0:3], v[40:43], 0
  v_mfma_f32_16x16x32_bf16 v[64:67], a[56:59], v[40:43], 0
  ds_read_b64_tr_b16 v[40:41], v17 offset:7168
  ds_read_b64_tr_b16 v[42:43], v17 offset:7280
  s_mul_i32 m0, s60, 14336
  s_add_u32 s82, s66, 896
  s_add_u32 m0, m0, s80
  s_nop 0
  buffer_load_dwordx4 v10, s[8:11], s82 offen lds
  s_add_u32 m0, s84, 32768
  s_nop 0
  buffer_load_dwordx4 v14, s[4:7], s73 offen lds
  s_waitcnt lgkmcnt(8)
  v_mfma_f32_16x16x32_bf16 v[60:63], a[0:3], v[44:47], 0
  v_mfma_f32_16x16x32_bf16 v[68:71], a[56:59], v[44:47], 0
  ds_read_b64_tr_b16 v[44:45], v17 offset:7200
  ds_read_b64_tr_b16 v[46:47], v17 offset:7312
  s_add_u32 m0, s84, 33792
  s_nop 0
  buffer_load_dwordx4 v15, s[4:7], s73 offen lds
  ds_read_b128 a[8:11], v18 offset:16384
  ds_read_b128 a[64:67], v18 offset:20480
  s_waitcnt lgkmcnt(10)
  s_waitcnt lgkmcnt(8)
  v_mfma_f32_16x16x32_bf16 v[56:59], a[4:7], v[48:51], v[56:59]
  v_cmp_gt_u32 vcc, 12, v2
  s_nop 1
  v_cndmask_b32 v21, 0, -1, vcc
  v_cmp_eq_u32 s[90:91], 12, v2
  v_mfma_f32_16x16x32_bf16 v[64:67], a[60:63], v[48:51], v[64:67]
  v_mov_b32 v26, 0x3f803f80
  v_lshlrev_b32 v20, 4, v3
  v_add_u32 v20, s71, v20
  ds_read_b64_tr_b16 v[48:49], v17 offset:10752
  ds_read_b64_tr_b16 v[50:51], v17 offset:10864
  s_mul_i32 m0, s60, 21504
  s_add_u32 s82, s67, 896
  s_add_u32 m0, m0, s80
  s_nop 0
  buffer_load_dwordx4 v10, s[8:11], s82 offen lds
  s_waitcnt lgkmcnt(8)
  v_mfma_f32_16x16x32_bf16 v[60:63], a[4:7], v[52:55], v[60:63]
  v_add_u32 v20, 159744, v20
  s_add_u32 s93, s63, 1
  s_cmp_eq_u32 s59, s58
  s_cselect_b32 s93, s93, 0
  s_mov_b32 s98, 0x3fb8aa3b
  v_mfma_f32_16x16x32_bf16 v[68:71], a[60:63], v[52:55], v[68:71]
  s_mov_b32 s99, 0x358637bd
  v_cmp_gt_u32 vcc, 3, v3
  s_nop 1
  v_cndmask_b32 v34, 0, -1, vcc
  ds_read_b64_tr_b16 v[52:53], v17 offset:10784
  ds_read_b64_tr_b16 v[54:55], v17 offset:10896
  ds_read_b128 a[12:15], v19 offset:16384
  ds_read_b128 a[68:71], v19 offset:20480
  s_waitcnt vmcnt(1)
  s_barrier
  s_cmp_ge_u32 s2, 8
  s_cbranch_scc1 L_nfB
  s_cmp_lg_u32 s59, 0
  s_cbranch_scc1 L_nfB
  s_lshl_b32 s86, s2, 2
  v_mov_b32 v36, 1
  s_mov_b64 exec, 1
  buffer_store_dword v36, off, s[28:31], s86 sc1
  s_mov_b64 exec, -1
L_nfB:
  s_waitcnt lgkmcnt(6)
  v_mfma_f32_16x16x32_bf16 v[56:59], a[8:11], v[40:43], v[56:59]
  v_lshrrev_b32 v4, 3, v1
  v_mul_u32_u24 v4, 896, v4
  v_lshlrev_b32 v5, 1, v3
  v_mfma_f32_16x16x32_bf16 v[64:67], a[64:67], v[40:43], v[64:67]
  v_and_b32 v6, 7, v1
  v_xor_b32 v5, v5, v6
  v_lshl_add_u32 v16, v5, 4, v4
  ds_read_b64_tr_b16 v[40:41], v17 offset:14336
  ds_read_b64_tr_b16 v[42:43], v17 offset:14448
  s_add_u32 m0, s84, 0
  s_nop 0
  buffer_load_dwordx4 v14, s[4:7], s74 offen lds
  v_mfma_f32_16x16x32_bf16 v[60:63], a[8:11], v[44:47], v[60:63]
  s_lshr_b32 s87, s78, 2
  s_lshl_b32 s87, s87, 7
  s_cmp_ge_u32 s78, 28
  s_cselect_b32 s87, 0x80000000, s87
  v_add_u32 v16, s87, v16
  v_mfma_f32_16x16x32_bf16 v[68:71], a[64:67], v[44:47], v[68:71]
  ds_read_b64_tr_b16 v[44:45], v17 offset:14368
  ds_read_b64_tr_b16 v[46:47], v17 offset:14480
  s_add_u32 m0, s84, 1024
  s_nop 0
  buffer_load_dwordx4 v15, s[4:7], s74 offen lds
  ds_read_b128 a[16:19], v18 offset:32768
  ds_read_b128 a[72:75], v18 offset:36864
  s_waitcnt lgkmcnt(6)
  v_mfma_f32_16x16x32_bf16 v[56:59], a[12:15], v[48:51], v[56:59]
  v_mfma_f32_16x16x32_bf16 v[64:67], a[68:71], v[48:51], v[64:67]
  ds_read_b64_tr_b16 v[48:49], v17 offset:17920
  ds_read_b64_tr_b16 v[50:51], v17 offset:18032
  s_mul_i32 m0, s60, 28672
  s_add_u32 s82, s68, 896
  s_add_u32 m0, m0, s80
  s_nop 0
  buffer_load_dwordx4 v10, s[8:11], s82 offen lds
  v_mfma_f32_16x16x32_bf16 v[60:63], a[12:15], v[52:55], v[60:63]
  v_mfma_f32_16x16x32_bf16 v[68:71], a[68:71], v[52:55], v[68:71]
  ds_read_b64_tr_b16 v[52:53], v17 offset:17952
  ds_read_b64_tr_b16 v[54:55], v17 offset:18064
  ds_read_b128 a[20:23], v19 offset:32768
  ds_read_b128 a[76:79], v19 offset:36864
  s_waitcnt vmcnt(1)
  s_barrier
  s_waitcnt lgkmcnt(6)
  v_mfma_f32_16x16x32_bf16 v[56:59], a[16:19], v[40:43], v[56:59]
  v_mfma_f32_16x16x32_bf16 v[64:67], a[72:75], v[40:43], v[64:67]
  ds_read_b64_tr_b16 v[40:41], v17 offset:21504
  ds_read_b64_tr_b16 v[42:43], v17 offset:21616
  s_add_u32 m0, s84, 16384
  s_nop 0
  buffer_load_dwordx4 v14, s[4:7], s75 offen lds
  v_mfma_f32_16x16x32_bf16 v[60:63], a[16:19], v[44:47], v[60:63]
  v_mfma_f32_16x16x32_bf16 v[68:71], a[72:75], v[44:47], v[68:71]
  ds_read_b64_tr_b16 v[44:45], v17 offset:21536
  ds_read_b64_tr_b16 v[46:47], v17 offset:21648
  s_add_u32 m0, s84, 17408
  s_nop 0
  buffer_load_dwordx4 v15, s[4:7], s75 offen lds
  ds_read_b128 a[24:27], v18 offset:0
  ds_read_b128 a[80:83], v18 offset:4096
  s_waitcnt lgkmcnt(6)
  v_mfma_f32_16x16x32_bf16 v[56:59], a[20:23], v[48:51], v[56:59]
  v_mfma_f32_16x16x32_bf16 v[64:67], a[76:79], v[48:51], v[64:67]
  ds_read_b64_tr_b16 v[48:49], v17 offset:25088
  ds_read_b64_tr_b16 v[50:51], v17 offset:25200
  s_mul_i32 m0, s60, 35840
  s_add_u32 s82, s69, 896
  s_add_u32 m0, m0, s80
  s_nop 0
  buffer_load_dwordx4 v10, s[8:11], s82 offen lds
  v_mfma_f32_16x16x32_bf16 v[60:63], a[20:23], v[52:55], v[60:63]
  v_mfma_f32_16x16x32_bf16 v[68:71], a[76:79], v[52:55], v[68:71]
  ds_read_b64_tr_b16 v[52:53], v17 offset:25120
  ds_read_b64_tr_b16 v[54:55], v17 offset:25232
  ds_read_b128 a[28:31], v19 offset:0
  ds_read_b128 a[84:87], v19 offset:4096
  v_lshlrev_b32 v37, 2, v1
  s_cmp_lg_u32 s59, 0
  s_cbranch_scc1 L_nlB
  s_mov_b64 exec, 0xff
  buffer_load_dword v36, v37, s[28:31], 0 offen sc1
  s_mov_b64 exec, -1
L_nlB:
  s_waitcnt vmcnt(1)
  s_barrier
  s_waitcnt lgkmcnt(6)
  v_mfma_f32_16x16x32_bf16 v[56:59], a[24:27], v[40:43], v[56:59]
  v_mfma_f32_16x16x32_bf16 v[64:67], a[80:83], v[40:43], v[64:67]
  ds_read_b64_tr_b16 v[40:41], v17 offset:28672
  ds_read_b64_tr_b16 v[42:43], v17 offset:28784
  s_add_u32 m0, s84, 32768
  s_nop 0
  buffer_load_dwordx4 v14, s[4:7], s76 offen lds
  v_mfma_f32_16x16x32_bf16 v[60:63], a[24:27], v[44:47], v[60:63]
  v_mfma_f32_16x16x32_bf16 v[68:71], a[80:83], v[44:47], v[68:71]
  ds_read_b64_tr_b16 v[44:45], v17 offset:28704
  ds_read_b64_tr_b16 v[46:47], v17 offset:28816
  s_add_u32 m0, s84, 33792
  s_nop 0
  buffer_load_dwordx4 v15, s[4:7], s76 offen lds
  ds_read_b128 a[32:35], v18 offset:16384
  ds_read_b128 a[88:91], v18 offset:20480
  s_waitcnt lgkmcnt(6)
  v_mfma_f32_16x16x32_bf16 v[56:59], a[28:31], v[48:51], v[56:59]
  v_mfma_f32_16x16x32_bf16 v[64:67], a[84:87], v[48:51], v[64:67]
  ds_read_b64_tr_b16 v[48:49], v17 offset:32256
  ds_read_b64_tr_b16 v[50:51], v17 offset:32368
  s_mul_i32 m0, s60, 43008
  s_add_u32 s82, s70, 896
  s_add_u32 m0, m0, s80
  s_nop 0
  buffer_load_dwordx4 v10, s[8:11], s82 offen lds
  v_mfma_f32_16x16x32_bf16 v[60:63], a[28:31], v[52:55], v[60:63]
  v_mfma_f32_16x16x32_bf16 v[68:71], a[84:87], v[52:55], v[68:71]
  ds_read_b64_tr_b16 v[52:53], v17 offset:32288
  ds_read_b64_tr_b16 v[54:55], v17 offset:32400
  ds_read_b128 a[36:39], v19 offset:16384
  ds_read_b128 a[92:95], v19 offset:20480
  s_waitcnt vmcnt(1)
  s_barrier
  s_waitcnt lgkmcnt(6)
  v_mfma_f32_16x16x32_bf16 v[56:59], a[32:35], v[40:43], v[56:59]
  v_mfma_f32_16x16x32_bf16 v[64:67], a[88:91], v[40:43], v[64:67]
  ds_read_b64_tr_b16 v[40:41], v17 offset:35840
  ds_read_b64_tr_b16 v[42:43], v17 offset:35952
  s_add_u32 m0, s84, 0
  s_nop 0
  buffer_load_dwordx4 v14, s[4:7], s77 offen lds
  v_mfma_f32_16x16x32_bf16 v[60:63], a[32:35], v[44:47], v[60:63]
  v_mfma_f32_16x16x32_bf16 v[68:71], a[88:91], v[44:47], v[68:71]
  ds_read_b64_tr_b16 v[44:45], v17 offset:35872
  ds_read_b64_tr_b16 v[46:47], v17 offset:35984
  s_add_u32 m0, s84, 1024
  s_nop 0
  buffer_load_dwordx4 v15, s[4:7], s77 offen lds
  ds_read_b128 a[40:43], v18 offset:32768
  ds_read_b128 a[96:99], v18 offset:36864
  s_waitcnt lgkmcnt(6)
  v_mfma_f32_16x16x32_bf16 v[56:59], a[36:39], v[48:51], v[56:59]
  v_mfma_f32_16x16x32_bf16 v[64:67], a[92:95], v[48:51], v[64:67]
  ds_read_b64_tr_b16 v[48:49], v17 offset:39424
  ds_read_b64_tr_b16 v[50:51], v17 offset:39536
  s_mul_i32 m0, s60, 50176
  s_add_u32 s82, s64, 1792
  s_add_u32 m0, m0, s80
  s_nop 0
  buffer_load_dwordx4 v10, s[8:11], s82 offen lds
  v_mfma_f32_16x16x32_bf16 v[60:63], a[36:39], v[52:55], v[60:63]
  v_mfma_f32_16x16x32_bf16 v[68:71], a[92:95], v[52:55], v[68:71]
  ds_read_b64_tr_b16 v[52:53], v17 offset:39456
  ds_read_b64_tr_b16 v[54:55], v17 offset:39568
  s_mul_i32 m0, s60, 0
  s_add_u32 s82, s65, 1792
  s_add_u32 m0, m0, s80
  s_nop 0
  buffer_load_dwordx4 v10, s[8:11], s82 offen lds
  ds_read_b128 a[44:47], v19 offset:32768
  ds_read_b128 a[100:103], v19 offset:36864
  s_waitcnt vmcnt(2)
  s_barrier
  s_waitcnt lgkmcnt(6)
  v_mfma_f32_16x16x32_bf16 v[56:59], a[40:43], v[40:43], v[56:59]
  v_mfma_f32_16x16x32_bf16 v[64:67], a[96:99], v[40:43], v[64:67]
  ds_read_b64_tr_b16 v[40:41], v17 offset:43008
  ds_read_b64_tr_b16 v[42:43], v17 offset:43120
  s_mul_i32 m0, s60, 7168
  s_add_u32 s82, s66, 1792
  s_add_u32 m0, m0, s80
  s_nop 0
  buffer_load_dwordx4 v10, s[8:11], s82 offen lds
  v_mfma_f32_16x16x32_bf16 v[60:63], a[40:43], v[44:47], v[60:63]
  v_mfma_f32_16x16x32_bf16 v[68:71], a[96:99], v[44:47], v[68:71]
  ds_read_b64_tr_b16 v[44:45], v17 offset:43040
  ds_read_b64_tr_b16 v[46:47], v17 offset:43152
  s_mul_i32 m0, s60, 14336
  s_add_u32 s82, s67, 1792
  s_add_u32 m0, m0, s80
  s_nop 0
  buffer_load_dwordx4 v10, s[8:11], s82 offen lds
  ds_read_b128 a[48:51], v18 offset:0
  ds_read_b128 a[104:107], v18 offset:4096
  s_waitcnt lgkmcnt(6)
  v_mfma_f32_16x16x32_bf16 v[56:59], a[44:47], v[48:51], v[56:59]
  v_mfma_f32_16x16x32_bf16 v[64:67], a[100:103], v[48:51], v[64:67]
  ds_read_b64_tr_b16 v[48:49], v17 offset:46592
  ds_read_b64_tr_b16 v[50:51], v17 offset:46704
  s_mul_i32 m0, s60, 21504
  s_add_u32 s82, s68, 1792
  s_add_u32 m0, m0, s80
  s_nop 0
  buffer_load_dwordx4 v10, s[8:11], s82 offen lds
  v_mfma_f32_16x16x32_bf16 v[60:63], a[44:47], v[52:55], v[60:63]
  v_mfma_f32_16x16x32_bf16 v[68:71], a[100:103], v[52:55], v[68:71]
  ds_read_b64_tr_b16 v[52:53], v17 offset:46624
  ds_read_b64_tr_b16 v[54:55], v17 offset:46736
  ds_read_b128 a[52:55], v19 offset:0
  ds_read_b128 a[108:111], v19 offset:4096
  s_waitcnt vmcnt(4)
  s_barrier
  s_waitcnt lgkmcnt(6)
  v_mfma_f32_16x16x32_bf16 v[56:59], a[48:51], v[40:43], v[56:59]
  v_mfma_f32_16x16x32_bf16 v[64:67], a[104:107], v[40:43], v[64:67]
  ds_read_b64_tr_b16 v[40:41], v17 offset:50176
  ds_read_b64_tr_b16 v[42:43], v17 offset:50288
  s_mul_i32 m0, s60, 28672
  s_add_u32 s82, s69, 1792
  s_add_u32 m0, m0, s80
  s_nop 0
  buffer_load_dwordx4 v10, s[8:11], s82 offen lds
  v_mfma_f32_16x16x32_bf16 v[60:63], a[48:51], v[44:47], v[60:63]
  v_mfma_f32_16x16x32_bf16 v[68:71], a[104:107], v[44:47], v[68:71]
  ds_read_b64_tr_b16 v[44:45], v17 offset:50208
  ds_read_b64_tr_b16 v[46:47], v17 offset:50320
  s_waitcnt lgkmcnt(4)
  v_mfma_f32_16x16x32_bf16 v[56:59], a[52:55], v[48:51], v[56:59]
  v_mfma_f32_16x16x32_bf16 v[64:67], a[108:111], v[48:51], v[64:67]
  ds_read_b64_tr_b16 v[48:49], v17 offset:53760
  ds_read_b64_tr_b16 v[50:51], v17 offset:53872
  s_mul_i32 m0, s60, 35840
  s_add_u32 s82, s70, 1792
  s_add_u32 m0, m0, s80
  s_nop 0
  buffer_load_dwordx4 v10, s[8:11], s82 offen lds
  v_mfma_f32_16x16x32_bf16 v[60:63], a[52:55], v[52:55], v[60:63]
  v_mfma_f32_16x16x32_bf16 v[68:71], a[108:111], v[52:55], v[68:71]
  ds_read_b64_tr_b16 v[52:53], v17 offset:53792
  ds_read_b64_tr_b16 v[54:55], v17 offset:53904
  s_and_b32 s86, s78, 3
  s_lshl_b32 s86, s86, 4
  s_add_u32 s86, s86, s59
  s_lshl_b32 s85, s86, 10
  s_mul_i32 s84, s85, 7
  s_waitcnt vmcnt(4)
  s_barrier
  s_waitcnt lgkmcnt(6)
  v_mfma_f32_16x16x32_bf16 v[72:75], a[0:3], v[40:43], 0
  v_mul_f32 v2, s98, v56
  v_mul_f32 v3, s98, v57
  v_mul_f32 v4, s98, v58
  v_mfma_f32_16x16x32_bf16 v[80:83], a[56:59], v[40:43], 0
  v_mul_f32 v5, s98, v59
  v_exp_f32 v2, -|v2|
  v_exp_f32 v3, -|v3|
  ds_read_b64_tr_b16 v[40:41], v17 offset:0
  ds_read_b64_tr_b16 v[42:43], v17 offset:112
  s_mul_i32 m0, s60, 114688
  s_add_u32 m0, m0, s80
  s_nop 0
  buffer_load_dwordx4 v10, s[8:11], s64 offen lds
  s_waitcnt lgkmcnt(6)
  v_mfma_f32_16x16x32_bf16 v[76:79], a[0:3], v[44:47], 0
  v_exp_f32 v4, -|v4|
  v_exp_f32 v5, -|v5|
  v_add_f32 v56, 1.0, v56
  v_mfma_f32_16x16x32_bf16 v[84:87], a[56:59], v[44:47], 0
  v_add_f32 v57, 1.0, v57
  v_add_f32 v58, 1.0, v58
  v_add_f32 v59, 1.0, v59
  ds_read_b64_tr_b16 v[44:45], v17 offset:32
  ds_read_b64_tr_b16 v[46:47], v17 offset:144
  s_waitcnt lgkmcnt(6)
  v_mfma_f32_16x16x32_bf16 v[72:75], a[4:7], v[48:51], v[72:75]
  v_max_f32 v56, v56, v2
  v_max_f32 v57, v57, v3
  v_max_f32 v58, v58, v4
  v_mfma_f32_16x16x32_bf16 v[80:83], a[60:63], v[48:51], v[80:83]
  v_max_f32 v59, v59, v5
  v_add_f32 v56, s99, v56
  v_add_f32 v57, s99, v57
  ds_read_b64_tr_b16 v[48:49], v17 offset:3584
  ds_read_b64_tr_b16 v[50:51], v17 offset:3696
  s_mul_i32 m0, s60, 121856
  s_add_u32 m0, m0, s80
  s_nop 0
  buffer_load_dwordx4 v10, s[8:11], s65 offen lds
  s_waitcnt lgkmcnt(6)
  v_mfma_f32_16x16x32_bf16 v[76:79], a[4:7], v[52:55], v[76:79]
  v_add_f32 v58, s99, v58
  v_add_f32 v59, s99, v59
  v_mul_f32 v6, s98, v64
  v_mfma_f32_16x16x32_bf16 v[84:87], a[60:63], v[52:55], v[84:87]
  v_mul_f32 v7, s98, v65
  v_mul_f32 v8, s98, v66
  v_mul_f32 v9, s98, v67
  ds_read_b64_tr_b16 v[52:53], v17 offset:3616
  ds_read_b64_tr_b16 v[54:55], v17 offset:3728
  s_waitcnt lgkmcnt(6)
  v_mfma_f32_16x16x32_bf16 v[72:75], a[8:11], v[40:43], v[72:75]
  v_exp_f32 v6, -|v6|
  v_exp_f32 v7, -|v7|
  v_exp_f32 v8, -|v8|
  v_mfma_f32_16x16x32_bf16 v[80:83], a[64:67], v[40:43], v[80:83]
  v_exp_f32 v9, -|v9|
  v_add_f32 v64, 1.0, v64
  v_add_f32 v65, 1.0, v65
  ds_read_b64_tr_b16 v[40:41], v17 offset:7168
  ds_read_b64_tr_b16 v[42:43], v17 offset:7280
  s_mul_i32 m0, s60, 129024
  s_add_u32 m0, m0, s80
  s_nop 0
  buffer_load_dwordx4 v10, s[8:11], s66 offen lds
  s_waitcnt lgkmcnt(6)
  v_mfma_f32_16x16x32_bf16 v[76:79], a[8:11], v[44:47], v[76:79]
  v_add_f32 v66, 1.0, v66
  v_add_f32 v67, 1.0, v67
  v_max_f32 v64, v64, v6
  v_mfma_f32_16x16x32_bf16 v[84:87], a[64:67], v[44:47], v[84:87]
  v_max_f32 v65, v65, v7
  v_max_f32 v66, v66, v8
  v_max_f32 v67, v67, v9
  ds_read_b64_tr_b16 v[44:45], v17 offset:7200
  ds_read_b64_tr_b16 v[46:47], v17 offset:7312
  s_waitcnt lgkmcnt(6)
  v_mfma_f32_16x16x32_bf16 v[72:75], a[12:15], v[48:51], v[72:75]
  v_add_f32 v64, s99, v64
  v_add_f32 v65, s99, v65
  v_add_f32 v66, s99, v66
  v_mfma_f32_16x16x32_bf16 v[80:83], a[68:71], v[48:51], v[80:83]
  v_add_f32 v67, s99, v67
  v_cvt_pk_bf16_f32 v108, v56, v57
  v_cvt_pk_bf16_f32 v109, v58, v59
  ds_read_b64_tr_b16 v[48:49], v17 offset:10752
  ds_read_b64_tr_b16 v[50:51], v17 offset:10864
  s_mul_i32 m0, s60, 136192
  s_add_u32 m0, m0, s80
  s_nop 0
  buffer_load_dwordx4 v10, s[8:11], s67 offen lds
  s_waitcnt lgkmcnt(6)
  v_mfma_f32_16x16x32_bf16 v[76:79], a[12:15], v[52:55], v[76:79]
  v_cvt_pk_bf16_f32 v110, v64, v65
  v_cvt_pk_bf16_f32 v111, v66, v67
  v_mul_f32 v2, s98, v60
  v_mfma_f32_16x16x32_bf16 v[84:87], a[68:71], v[52:55], v[84:87]
  v_mul_f32 v3, s98, v61
  v_mul_f32 v4, s98, v62
  v_mul_f32 v5, s98, v63
  ds_read_b64_tr_b16 v[52:53], v17 offset:10784
  ds_read_b64_tr_b16 v[54:55], v17 offset:10896
  s_waitcnt vmcnt(4)
  s_barrier
  s_waitcnt lgkmcnt(6)
  v_mfma_f32_16x16x32_bf16 v[72:75], a[16:19], v[40:43], v[72:75]
  v_exp_f32 v2, -|v2|
  v_exp_f32 v3, -|v3|
  v_exp_f32 v4, -|v4|
  v_mfma_f32_16x16x32_bf16 v[80:83], a[72:75], v[40:43], v[80:83]
  v_exp_f32 v5, -|v5|
  v_add_f32 v60, 1.0, v60
  v_add_f32 v61, 1.0, v61
  ds_read_b64_tr_b16 v[40:41], v17 offset:14336
  ds_read_b64_tr_b16 v[42:43], v17 offset:14448
  s_mul_i32 m0, s60, 143360
  s_add_u32 m0, m0, s80
  s_nop 0
  buffer_load_dwordx4 v10, s[8:11], s68 offen lds
  s_waitcnt lgkmcnt(6)
  v_mfma_f32_16x16x32_bf16 v[76:79], a[16:19], v[44:47], v[76:79]
  v_add_f32 v62, 1.0, v62
  v_add_f32 v63, 1.0, v63
  v_max_f32 v60, v60, v2
  v_mfma_f32_16x16x32_bf16 v[84:87], a[72:75], v[44:47], v[84:87]
  v_max_f32 v61, v61, v3
  v_max_f32 v62, v62, v4
  v_max_f32 v63, v63, v5
  ds_read_b64_tr_b16 v[44:45], v17 offset:14368
  ds_read_b64_tr_b16 v[46:47], v17 offset:14480
  s_waitcnt lgkmcnt(6)
  v_mfma_f32_16x16x32_bf16 v[72:75], a[20:23], v[48:51], v[72:75]
  v_add_f32 v60, s99, v60
  v_add_f32 v61, s99, v61
  v_add_f32 v62, s99, v62
  v_mfma_f32_16x16x32_bf16 v[80:83], a[76:79], v[48:51], v[80:83]
  v_add_f32 v63, s99, v63
  v_mul_f32 v6, s98, v68
  v_mul_f32 v7, s98, v69
  ds_read_b64_tr_b16 v[48:49], v17 offset:17920
  ds_read_b64_tr_b16 v[50:51], v17 offset:18032
  s_add_u32 m0, s85, 57344
  s_nop 0
  buffer_load_dwordx4 v16, s[20:23], s84 offen lds
  s_add_u32 s85, s85, 8192
  s_cmp_ge_u32 s85, 57344
  s_cselect_b32 s83, 57344, 0
  s_sub_u32 s85, s85, s83
  s_mul_i32 s84, s85, 7
  s_waitcnt lgkmcnt(6)
  v_mfma_f32_16x16x32_bf16 v[76:79], a[20:23], v[52:55], v[76:79]
  v_mul_f32 v8, s98, v70
  v_mul_f32 v9, s98, v71
  v_exp_f32 v6, -|v6|
  v_mfma_f32_16x16x32_bf16 v[84:87], a[76:79], v[52:55], v[84:87]
  v_exp_f32 v7, -|v7|
  v_exp_f32 v8, -|v8|
  v_exp_f32 v9, -|v9|
  ds_read_b64_tr_b16 v[52:53], v17 offset:17952
  ds_read_b64_tr_b16 v[54:55], v17 offset:18064
  s_waitcnt lgkmcnt(6)
  v_mfma_f32_16x16x32_bf16 v[72:75], a[24:27], v[40:43], v[72:75]
  v_add_f32 v68, 1.0, v68
  v_add_f32 v69, 1.0, v69
  v_add_f32 v70, 1.0, v70
  v_mfma_f32_16x16x32_bf16 v[80:83], a[80:83], v[40:43], v[80:83]
  v_add_f32 v71, 1.0, v71
  v_max_f32 v68, v68, v6
  v_max_f32 v69, v69, v7
  ds_read_b64_tr_b16 v[40:41], v17 offset:21504
  ds_read_b64_tr_b16 v[42:43], v17 offset:21616
  s_add_u32 m0, s85, 57344
  s_nop 0
  buffer_load_dwordx4 v16, s[20:23], s84 offen lds
  s_add_u32 s85, s85, 8192
  s_cmp_ge_u32 s85, 57344
  s_cselect_b32 s83, 57344, 0
  s_sub_u32 s85, s85, s83
  s_mul_i32 s84, s85, 7
  s_waitcnt lgkmcnt(6)
  v_mfma_f32_16x16x32_bf16 v[76:79], a[24:27], v[44:47], v[76:79]
  v_max_f32 v70, v70, v8
  v_max_f32 v71, v71, v9
  v_add_f32 v68, s99, v68
  v_mfma_f32_16x16x32_bf16 v[84:87], a[80:83], v[44:47], v[84:87]
  v_add_f32 v69, s99, v69
  v_add_f32 v70, s99, v70
  v_add_f32 v71, s99, v71
  ds_read_b64_tr_b16 v[44:45], v17 offset:21536
  ds_read_b64_tr_b16 v[46:47], v17 offset:21648
  s_waitcnt lgkmcnt(6)
  v_mfma_f32_16x16x32_bf16 v[72:75], a[28:31], v[48:51], v[72:75]
  v_cvt_pk_bf16_f32 v112, v60, v61
  v_cvt_pk_bf16_f32 v113, v62, v63
  v_cvt_pk_bf16_f32 v114, v68, v69
  v_mfma_f32_16x16x32_bf16 v[80:83], a[84:87], v[48:51], v[80:83]
  v_cvt_pk_bf16_f32 v115, v70, v71
  v_and_b32 v112, v21, v112
  v_and_b32 v113, v21, v113
  ds_read_b64_tr_b16 v[48:49], v17 offset:25088
  ds_read_b64_tr_b16 v[50:51], v17 offset:25200
  s_add_u32 m0, s85, 57344
  s_nop 0
  buffer_load_dwordx4 v16, s[20:23], s84 offen lds
  s_add_u32 s85, s85, 8192
  s_cmp_ge_u32 s85, 57344
  s_cselect_b32 s83, 57344, 0
  s_sub_u32 s85, s85, s83
  s_mul_i32 s84, s85, 7
  s_waitcnt lgkmcnt(6)
  v_mfma_f32_16x16x32_bf16 v[76:79], a[28:31], v[52:55], v[76:79]
  v_and_b32 v114, v21, v114
  v_and_b32 v115, v21, v115
  s_lshl_b32 s86, s62, 1
  v_mfma_f32_16x16x32_bf16 v[84:87], a[84:87], v[52:55], v[84:87]
  s_add_u32 s86, s86, s61
  s_lshl_b32 s86, s86, 13
  s_lshl_b32 s87, s63, 12
  ds_read_b64_tr_b16 v[52:53], v17 offset:25120
  ds_read_b64_tr_b16 v[54:55], v17 offset:25232
  s_waitcnt lgkmcnt(6)
  v_mfma_f32_16x16x32_bf16 v[72:75], a[32:35], v[40:43], v[72:75]
  s_add_u32 s86, s86, s87
  v_add_u32 v38, s86, v35
  s_lshl_b32 s86, s59, 10
  v_mfma_f32_16x16x32_bf16 v[80:83], a[88:91], v[40:43], v[80:83]
  v_lshlrev_b32 v39, 2, v1
  v_add_u32 v39, s86, v39
  s_lshl_b32 s87, s58, 13
  ds_read_b64_tr_b16 v[40:41], v17 offset:28672
  ds_read_b64_tr_b16 v[42:43], v17 offset:28784
  s_add_u32 m0, s85, 57344
  s_nop 0
  buffer_load_dwordx4 v16, s[20:23], s84 offen lds
  s_add_u32 s85, s85, 8192
  s_cmp_ge_u32 s85, 57344
  s_cselect_b32 s83, 57344, 0
  s_sub_u32 s85, s85, s83
  s_mul_i32 s84, s85, 7
  s_waitcnt lgkmcnt(6)
  v_mfma_f32_16x16x32_bf16 v[76:79], a[32:35], v[44:47], v[76:79]
  s_add_u32 s87, s87, 4194304
  s_lshl_b32 s92, s58, 10
  s_add_u32 s92, s92, 4259840
  v_mfma_f32_16x16x32_bf16 v[84:87], a[88:91], v[44:47], v[84:87]
  ds_read_b64_tr_b16 v[44:45], v17 offset:28704
  ds_read_b64_tr_b16 v[46:47], v17 offset:28816
  s_waitcnt lgkmcnt(6)
  v_mfma_f32_16x16x32_bf16 v[72:75], a[36:39], v[48:51], v[72:75]
  v_mfma_f32_16x16x32_bf16 v[80:83], a[92:95], v[48:51], v[80:83]
  ds_read_b64_tr_b16 v[48:49], v17 offset:32256
  ds_read_b64_tr_b16 v[50:51], v17 offset:32368
  s_add_u32 m0, s85, 57344
  s_nop 0
  buffer_load_dwordx4 v16, s[20:23], s84 offen lds
  s_add_u32 s85, s85, 8192
  s_cmp_ge_u32 s85, 57344
  s_cselect_b32 s83, 57344, 0
  s_sub_u32 s85, s85, s83
  s_mul_i32 s84, s85, 7
  s_waitcnt lgkmcnt(6)
  v_mfma_f32_16x16x32_bf16 v[76:79], a[36:39], v[52:55], v[76:79]
  v_mfma_f32_16x16x32_bf16 v[84:87], a[92:95], v[52:55], v[84:87]
  ds_read_b64_tr_b16 v[52:53], v17 offset:32288
  ds_read_b64_tr_b16 v[54:55], v17 offset:32400
  s_waitcnt lgkmcnt(6)
  v_mfma_f32_16x16x32_bf16 v[72:75], a[40:43], v[40:43], v[72:75]
  v_mfma_f32_16x16x32_bf16 v[80:83], a[96:99], v[40:43], v[80:83]
  ds_read_b64_tr_b16 v[40:41], v17 offset:35840
  ds_read_b64_tr_b16 v[42:43], v17 offset:35952
  s_add_u32 m0, s85, 57344
  s_nop 0
  buffer_load_dwordx4 v16, s[20:23], s84 offen lds
  s_add_u32 s85, s85, 8192
  s_cmp_ge_u32 s85, 57344
  s_cselect_b32 s83, 57344, 0
  s_sub_u32 s85, s85, s83
  s_mul_i32 s84, s85, 7
  s_waitcnt lgkmcnt(6)
  v_mfma_f32_16x16x32_bf16 v[76:79], a[40:43], v[44:47], v[76:79]
  v_mfma_f32_16x16x32_bf16 v[84:87], a[96:99], v[44:47], v[84:87]
  ds_read_b64_tr_b16 v[44:45], v17 offset:35872
  ds_read_b64_tr_b16 v[46:47], v17 offset:35984
  s_waitcnt lgkmcnt(6)
  v_mfma_f32_16x16x32_bf16 v[72:75], a[44:47], v[48:51], v[72:75]
  v_mfma_f32_16x16x32_bf16 v[80:83], a[100:103], v[48:51], v[80:83]
  ds_read_b64_tr_b16 v[48:49], v17 offset:39424
  ds_read_b64_tr_b16 v[50:51], v17 offset:39536
  s_add_u32 m0, s85, 57344
  s_nop 0
  buffer_load_dwordx4 v16, s[20:23], s84 offen lds
  s_add_u32 s85, s85, 8192
  s_cmp_ge_u32 s85, 57344
  s_cselect_b32 s83, 57344, 0
  s_sub_u32 s85, s85, s83
  s_mul_i32 s84, s85, 7
  s_waitcnt lgkmcnt(6)
  v_mfma_f32_16x16x32_bf16 v[76:79], a[44:47], v[52:55], v[76:79]
  v_mfma_f32_16x16x32_bf16 v[84:87], a[100:103], v[52:55], v[84:87]
  ds_read_b64_tr_b16 v[52:53], v17 offset:39456
  ds_read_b64_tr_b16 v[54:55], v17 offset:39568
  s_waitcnt vmcnt(9)
  s_barrier
  s_waitcnt lgkmcnt(6)
  v_mfma_f32_16x16x32_bf16 v[72:75], a[48:51], v[40:43], v[72:75]
  v_mfma_f32_16x16x32_bf16 v[80:83], a[104:107], v[40:43], v[80:83]
  v_add_u32 v17, 114688, v17
  ds_read_b64_tr_b16 v[40:41], v17 offset:0
  ds_read_b64_tr_b16 v[42:43], v17 offset:112
  s_waitcnt lgkmcnt(6)
  v_mfma_f32_16x16x32_bf16 v[76:79], a[48:51], v[44:47], v[76:79]
  v_mfma_f32_16x16x32_bf16 v[84:87], a[104:107], v[44:47], v[84:87]
  ds_read_b64_tr_b16 v[44:45], v17 offset:32
  ds_read_b64_tr_b16 v[46:47], v17 offset:144
  s_waitcnt lgkmcnt(6)
  v_mfma_f32_16x16x32_bf16 v[72:75], a[52:55], v[48:51], v[72:75]
  v_mfma_f32_16x16x32_bf16 v[80:83], a[108:111], v[48:51], v[80:83]
  ds_read_b64_tr_b16 v[48:49], v17 offset:3584
  ds_read_b64_tr_b16 v[50:51], v17 offset:3696
  s_waitcnt lgkmcnt(6)
  v_mfma_f32_16x16x32_bf16 v[76:79], a[52:55], v[52:55], v[76:79]
  v_mfma_f32_16x16x32_bf16 v[84:87], a[108:111], v[52:55], v[84:87]
  ds_read_b64_tr_b16 v[52:53], v17 offset:3616
  ds_read_b64_tr_b16 v[54:55], v17 offset:3728
  s_cmp_eq_u32 s93, 0
  s_cbranch_scc1 L_g8
  ds_read_b128 v[124:127], v20 offset:0
L_g8:
  s_nop 1
  v_cvt_pk_bf16_f32 v120, v76, v77
  v_cvt_pk_bf16_f32 v121, v78, v79
  v_cvt_pk_bf16_f32 v122, v84, v85
  v_cvt_pk_bf16_f32 v123, v86, v87
  v_cndmask_b32 v120, v120, v26, s[90:91]
  v_cndmask_b32 v121, v121, v26, s[90:91]
  v_cndmask_b32 v122, v122, v26, s[90:91]
  v_cndmask_b32 v123, v123, v26, s[90:91]
  v_cvt_pk_bf16_f32 v116, v72, v73
  v_cvt_pk_bf16_f32 v117, v74, v75
  v_cvt_pk_bf16_f32 v118, v80, v81
  v_cvt_pk_bf16_f32 v119, v82, v83
  s_nop 1
  v_mfma_f32_16x16x32_bf16 v[56:59], v[108:111], v[116:119], 0
  v_mfma_f32_16x16x32_bf16 v[60:63], v[112:115], v[116:119], 0
  v_mfma_f32_16x16x32_bf16 v[64:67], v[108:111], v[120:123], 0
  v_mfma_f32_16x16x32_bf16 v[68:71], v[112:115], v[120:123], 0
  s_nop 4
  ds_write_b128 v38, v[56:59] offset:0
  ds_write_b128 v38, v[60:63] offset:1024
  ds_write_b128 v38, v[64:67] offset:2048
  ds_write_b128 v38, v[68:71] offset:3072
  s_cmp_lg_u32 s59, 0
  s_cbranch_scc1 L_ncB
  s_mov_b64 exec, 0xff
  s_mov_b32 s3, 0
L_fcB:
  v_cmp_eq_u32 vcc, 0, v36
  s_nop 3
  s_cbranch_vccz L_fokB
  s_add_u32 s3, s3, 1
  s_cmp_ge_u32 s3, 524288
  s_cbranch_scc1 L_fokB
  s_sleep 2
  buffer_load_dword v36, v37, s[28:31], 0 offen sc1
  s_waitcnt vmcnt(0)
  s_branch L_fcB
L_fokB:
  s_mov_b64 exec, -1
L_ncB:
  s_waitcnt lgkmcnt(0)
  s_barrier
  ds_read_b32 v72, v39 offset:0
  ds_read_b32 v73, v39 offset:8192
  ds_read_b32 v74, v39 offset:16384
  ds_read_b32 v75, v39 offset:24576
  ds_read_b32 v76, v39 offset:256
  ds_read_b32 v77, v39 offset:8448
  ds_read_b32 v78, v39 offset:16640
  ds_read_b32 v79, v39 offset:24832
  ds_read_b32 v80, v39 offset:512
  ds_read_b32 v81, v39 offset:8704
  ds_read_b32 v82, v39 offset:16896
  ds_read_b32 v83, v39 offset:25088
  ds_read_b32 v84, v39 offset:768
  ds_read_b32 v85, v39 offset:8960
  ds_read_b32 v86, v39 offset:17152
  ds_read_b32 v87, v39 offset:25344
  s_waitcnt lgkmcnt(12)
  v_add_f32 v72, v72, v73
  v_add_f32 v74, v74, v75
  v_add_f32 v72, v72, v74
  buffer_atomic_add_f32 v72, v39, s[12:15], s87 offen offset:0
  s_waitcnt lgkmcnt(8)
  v_add_f32 v76, v76, v77
  v_add_f32 v78, v78, v79
  v_add_f32 v76, v76, v78
  buffer_atomic_add_f32 v76, v39, s[12:15], s87 offen offset:256
  s_waitcnt lgkmcnt(4)
  v_add_f32 v80, v80, v81
  v_add_f32 v82, v82, v83
  v_add_f32 v80, v80, v82
  buffer_atomic_add_f32 v80, v39, s[12:15], s87 offen offset:512
  s_waitcnt lgkmcnt(0)
  v_add_f32 v84, v84, v85
  v_add_f32 v86, v86, v87
  v_add_f32 v84, v84, v86
  buffer_atomic_add_f32 v84, v39, s[12:15], s87 offen offset:768
  v_mfma_f32_16x16x32_bf16 v[88:91], v[40:43], a[0:3], 0
  v_mfma_f32_16x16x32_bf16 v[96:99], v[40:43], a[56:59], 0
  ds_read_b64_tr_b16 v[40:41], v17 offset:7168
  ds_read_b64_tr_b16 v[42:43], v17 offset:7280
  v_mfma_f32_16x16x32_bf16 v[92:95], v[44:47], a[0:3], 0
  v_mfma_f32_16x16x32_bf16 v[100:103], v[44:47], a[56:59], 0
  ds_read_b64_tr_b16 v[44:45], v17 offset:7200
  ds_read_b64_tr_b16 v[46:47], v17 offset:7312
  s_cmp_eq_u32 s93, 0
  s_cbranch_scc1 L_g9
  s_waitcnt lgkmcnt(15)
  s_cmp_eq_u32 s93, 1
  s_cbranch_scc1 L_g9a
  v_mfma_f32_16x16x32_bf16 v[104:107], v[124:127], a[56:59], 0
  s_branch L_g9b
L_g9a:
  v_mfma_f32_16x16x32_bf16 v[104:107], v[124:127], a[0:3], 0
L_g9b:
  ds_read_b128 v[128:131], v20 offset:64
L_g9:
  v_mfma_f32_16x16x32_bf16 v[88:91], v[48:51], a[4:7], v[88:91]
  v_mfma_f32_16x16x32_bf16 v[96:99], v[48:51], a[60:63], v[96:99]
  ds_read_b64_tr_b16 v[48:49], v17 offset:10752
  ds_read_b64_tr_b16 v[50:51], v17 offset:10864
  v_mfma_f32_16x16x32_bf16 v[92:95], v[52:55], a[4:7], v[92:95]
  v_mfma_f32_16x16x32_bf16 v[100:103], v[52:55], a[60:63], v[100:103]
  ds_read_b64_tr_b16 v[52:53], v17 offset:10784
  ds_read_b64_tr_b16 v[54:55], v17 offset:10896
  s_cmp_eq_u32 s93, 0
  s_cbranch_scc1 L_g10
  s_waitcnt lgkmcnt(4)
  s_cmp_eq_u32 s93, 1
  s_cbranch_scc1 L_g10a
  v_mfma_f32_16x16x32_bf16 v[104:107], v[128:131], a[60:63], v[104:107]
  s_branch L_g10b
L_g10a:
  v_mfma_f32_16x16x32_bf16 v[104:107], v[128:131], a[4:7], v[104:107]
L_g10b:
  ds_read_b128 v[124:127], v20 offset:128
L_g10:
  s_waitcnt lgkmcnt(6)
  v_mfma_f32_16x16x32_bf16 v[88:91], v[40:43], a[8:11], v[88:91]
  v_mfma_f32_16x16x32_bf16 v[96:99], v[40:43], a[64:67], v[96:99]
  ds_read_b64_tr_b16 v[40:41], v17 offset:14336
  ds_read_b64_tr_b16 v[42:43], v17 offset:14448
  s_waitcnt lgkmcnt(6)
  v_mfma_f32_16x16x32_bf16 v[92:95], v[44:47], a[8:11], v[92:95]
  v_mfma_f32_16x16x32_bf16 v[100:103], v[44:47], a[64:67], v[100:103]
  ds_read_b64_tr_b16 v[44:45], v17 offset:14368
  ds_read_b64_tr_b16 v[46:47], v17 offset:14480
  s_cmp_eq_u32 s93, 0
  s_cbranch_scc1 L_g11
  s_waitcnt lgkmcnt(4)
  s_cmp_eq_u32 s93, 1
  s_cbranch_scc1 L_g11a
  v_mfma_f32_16x16x32_bf16 v[104:107], v[124:127], a[64:67], v[104:107]
  s_branch L_g11b
L_g11a:
  v_mfma_f32_16x16x32_bf16 v[104:107], v[124:127], a[8:11], v[104:107]
L_g11b:
  ds_read_b128 v[128:131], v20 offset:192
L_g11:
  s_waitcnt lgkmcnt(6)
  v_mfma_f32_16x16x32_bf16 v[88:91], v[48:51], a[12:15], v[88:91]
  v_mfma_f32_16x16x32_bf16 v[96:99], v[48:51], a[68:71], v[96:99]
  ds_read_b64_tr_b16 v[48:49], v17 offset:17920
  ds_read_b64_tr_b16 v[50:51], v17 offset:18032
  s_waitcnt lgkmcnt(6)
  v_mfma_f32_16x16x32_bf16 v[92:95], v[52:55], a[12:15], v[92:95]
  v_mfma_f32_16x16x32_bf16 v[100:103], v[52:55], a[68:71], v[100:103]
  ds_read_b64_tr_b16 v[52:53], v17 offset:17952
  ds_read_b64_tr_b16 v[54:55], v17 offset:18064
  s_cmp_eq_u32 s93, 0
  s_cbranch_scc1 L_g12
  s_waitcnt lgkmcnt(4)
  s_cmp_eq_u32 s93, 1
  s_cbranch_scc1 L_g12a
  v_mfma_f32_16x16x32_bf16 v[104:107], v[128:131], a[68:71], v[104:107]
  s_branch L_g12b
L_g12a:
  v_mfma_f32_16x16x32_bf16 v[104:107], v[128:131], a[12:15], v[104:107]
L_g12b:
  ds_read_b128 v[124:127], v20 offset:256
L_g12:
  s_waitcnt vmcnt(0)
  s_barrier
  s_cmp_lg_u32 s59, 0
  s_cbranch_scc1 L_kvadd
  v_mov_b32 v36, 1
  s_mov_b64 exec, 1
  buffer_atomic_add v36, off, s[12:15], s92
  s_mov_b64 exec, -1
L_kvadd:
  s_waitcnt lgkmcnt(6)
  v_mfma_f32_16x16x32_bf16 v[88:91], v[40:43], a[16:19], v[88:91]
  v_mfma_f32_16x16x32_bf16 v[96:99], v[40:43], a[72:75], v[96:99]
  ds_read_b64_tr_b16 v[40:41], v17 offset:21504
  ds_read_b64_tr_b16 v[42:43], v17 offset:21616
  s_mul_i32 m0, s60, 114688
  s_add_u32 m0, m0, s80
  s_nop 0
  buffer_load_dwordx4 v10, s[8:11], s69 offen lds
  s_waitcnt lgkmcnt(6)
  v_mfma_f32_16x16x32_bf16 v[92:95], v[44:47], a[16:19], v[92:95]
  v_mfma_f32_16x16x32_bf16 v[100:103], v[44:47], a[72:75], v[100:103]
  ds_read_b64_tr_b16 v[44:45], v17 offset:21536
  ds_read_b64_tr_b16 v[46:47], v17 offset:21648
  s_mul_i32 m0, s60, 121856
  s_add_u32 m0, m0, s80
  s_nop 0
  buffer_load_dwordx4 v10, s[8:11], s70 offen lds
  s_cmp_eq_u32 s93, 0
  s_cbranch_scc1 L_g13
  s_waitcnt lgkmcnt(4)
  s_cmp_eq_u32 s93, 1
  s_cbranch_scc1 L_g13a
  v_mfma_f32_16x16x32_bf16 v[104:107], v[124:127], a[72:75], v[104:107]
  s_branch L_g13b
L_g13a:
  v_mfma_f32_16x16x32_bf16 v[104:107], v[124:127], a[16:19], v[104:107]
L_g13b:
  ds_read_b128 v[128:131], v20 offset:320
L_g13:
  s_waitcnt lgkmcnt(6)
  v_mfma_f32_16x16x32_bf16 v[88:91], v[48:51], a[20:23], v[88:91]
  v_mfma_f32_16x16x32_bf16 v[96:99], v[48:51], a[76:79], v[96:99]
  ds_read_b64_tr_b16 v[48:49], v17 offset:25088
  ds_read_b64_tr_b16 v[50:51], v17 offset:25200
  s_add_u32 m0, s85, 0
  s_nop 0
  buffer_load_dwordx4 v16, s[16:19], s84 offen lds
  s_add_u32 s85, s85, 8192
  s_cmp_ge_u32 s85, 57344
  s_cselect_b32 s83, 57344, 0
  s_sub_u32 s85, s85, s83
  s_mul_i32 s84, s85, 7
  s_waitcnt lgkmcnt(6)
  v_mfma_f32_16x16x32_bf16 v[92:95], v[52:55], a[20:23], v[92:95]
  v_mfma_f32_16x16x32_bf16 v[100:103], v[52:55], a[76:79], v[100:103]
  ds_read_b64_tr_b16 v[52:53], v17 offset:25120
  ds_read_b64_tr_b16 v[54:55], v17 offset:25232
  s_cmp_eq_u32 s93, 0
  s_cbranch_scc1 L_g14
  s_waitcnt lgkmcnt(4)
  s_cmp_eq_u32 s93, 1
  s_cbranch_scc1 L_g14a
  v_mfma_f32_16x16x32_bf16 v[104:107], v[128:131], a[76:79], v[104:107]
  s_branch L_g14b
L_g14a:
  v_mfma_f32_16x16x32_bf16 v[104:107], v[128:131], a[20:23], v[104:107]
L_g14b:
  ds_read_b128 v[124:127], v20 offset:384
L_g14:
  s_waitcnt lgkmcnt(6)
  v_mfma_f32_16x16x32_bf16 v[88:91], v[40:43], a[24:27], v[88:91]
  v_mfma_f32_16x16x32_bf16 v[96:99], v[40:43], a[80:83], v[96:99]
  ds_read_b64_tr_b16 v[40:41], v17 offset:28672
  ds_read_b64_tr_b16 v[42:43], v17 offset:28784
  s_add_u32 m0, s85, 0
  s_nop 0
  buffer_load_dwordx4 v16, s[16:19], s84 offen lds
  s_add_u32 s85, s85, 8192
  s_cmp_ge_u32 s85, 57344
  s_cselect_b32 s83, 57344, 0
  s_sub_u32 s85, s85, s83
  s_mul_i32 s84, s85, 7
  s_waitcnt lgkmcnt(6)
  v_mfma_f32_16x16x32_bf16 v[92:95], v[44:47], a[24:27], v[92:95]
  v_mfma_f32_16x16x32_bf16 v[100:103], v[44:47], a[80:83], v[100:103]
  ds_read_b64_tr_b16 v[44:45], v17 offset:28704
  ds_read_b64_tr_b16 v[46:47], v17 offset:28816
  s_cmp_eq_u32 s93, 0
  s_cbranch_scc1 L_g15
  s_waitcnt lgkmcnt(4)
  s_cmp_eq_u32 s93, 1
  s_cbranch_scc1 L_g15a
  v_mfma_f32_16x16x32_bf16 v[104:107], v[124:127], a[80:83], v[104:107]
  s_branch L_g15b
L_g15a:
  v_mfma_f32_16x16x32_bf16 v[104:107], v[124:127], a[24:27], v[104:107]
L_g15b:
  ds_read_b128 v[128:131], v20 offset:448
L_g15:
  s_waitcnt lgkmcnt(6)
  v_mfma_f32_16x16x32_bf16 v[88:91], v[48:51], a[28:31], v[88:91]
  v_mfma_f32_16x16x32_bf16 v[96:99], v[48:51], a[84:87], v[96:99]
  ds_read_b64_tr_b16 v[48:49], v17 offset:32256
  ds_read_b64_tr_b16 v[50:51], v17 offset:32368
  s_add_u32 m0, s85, 0
  s_nop 0
  buffer_load_dwordx4 v16, s[16:19], s84 offen lds
  s_add_u32 s85, s85, 8192
  s_cmp_ge_u32 s85, 57344
  s_cselect_b32 s83, 57344, 0
  s_sub_u32 s85, s85, s83
  s_mul_i32 s84, s85, 7
  s_waitcnt lgkmcnt(6)
  v_mfma_f32_16x16x32_bf16 v[92:95], v[52:55], a[28:31], v[92:95]
  v_mfma_f32_16x16x32_bf16 v[100:103], v[52:55], a[84:87], v[100:103]
  ds_read_b64_tr_b16 v[52:53], v17 offset:32288
  ds_read_b64_tr_b16 v[54:55], v17 offset:32400
  s_cmp_eq_u32 s93, 0
  s_cbranch_scc1 L_g16
  s_waitcnt lgkmcnt(4)
  s_cmp_eq_u32 s93, 1
  s_cbranch_scc1 L_g16a
  v_mfma_f32_16x16x32_bf16 v[104:107], v[128:131], a[84:87], v[104:107]
  s_branch L_g16b
L_g16a:
  v_mfma_f32_16x16x32_bf16 v[104:107], v[128:131], a[28:31], v[104:107]
L_g16b:
  ds_read_b128 v[124:127], v20 offset:512
L_g16:
  s_waitcnt vmcnt(3)
  s_barrier
  s_waitcnt lgkmcnt(6)
  v_mfma_f32_16x16x32_bf16 v[88:91], v[40:43], a[32:35], v[88:91]
  v_mfma_f32_16x16x32_bf16 v[96:99], v[40:43], a[88:91], v[96:99]
  ds_read_b64_tr_b16 v[40:41], v17 offset:0
  ds_read_b64_tr_b16 v[42:43], v17 offset:112
  s_add_u32 m0, s85, 0
  s_nop 0
  buffer_load_dwordx4 v16, s[16:19], s84 offen lds
  s_add_u32 s85, s85, 8192
  s_cmp_ge_u32 s85, 57344
  s_cselect_b32 s83, 57344, 0
  s_sub_u32 s85, s85, s83
  s_mul_i32 s84, s85, 7
  s_waitcnt lgkmcnt(6)
  v_mfma_f32_16x16x32_bf16 v[92:95], v[44:47], a[32:35], v[92:95]
  v_mfma_f32_16x16x32_bf16 v[100:103], v[44:47], a[88:91], v[100:103]
  ds_read_b64_tr_b16 v[44:45], v17 offset:32
  ds_read_b64_tr_b16 v[46:47], v17 offset:144
  s_cmp_eq_u32 s93, 0
  s_cbranch_scc1 L_g17
  s_waitcnt lgkmcnt(4)
  s_cmp_eq_u32 s93, 1
  s_cbranch_scc1 L_g17a
  v_mfma_f32_16x16x32_bf16 v[104:107], v[124:127], a[88:91], v[104:107]
  s_branch L_g17b
L_g17a:
  v_mfma_f32_16x16x32_bf16 v[104:107], v[124:127], a[32:35], v[104:107]
L_g17b:
  ds_read_b128 v[128:131], v20 offset:576
L_g17:
  s_waitcnt lgkmcnt(6)
  v_mfma_f32_16x16x32_bf16 v[88:91], v[48:51], a[36:39], v[88:91]
  v_mfma_f32_16x16x32_bf16 v[96:99], v[48:51], a[92:95], v[96:99]
  ds_read_b64_tr_b16 v[48:49], v17 offset:3584
  ds_read_b64_tr_b16 v[50:51], v17 offset:3696
  s_add_u32 m0, s85, 0
  s_nop 0
  buffer_load_dwordx4 v16, s[16:19], s84 offen lds
  s_add_u32 s85, s85, 8192
  s_cmp_ge_u32 s85, 57344
  s_cselect_b32 s83, 57344, 0
  s_sub_u32 s85, s85, s83
  s_mul_i32 s84, s85, 7
  s_waitcnt lgkmcnt(6)
  v_mfma_f32_16x16x32_bf16 v[92:95], v[52:55], a[36:39], v[92:95]
  v_mfma_f32_16x16x32_bf16 v[100:103], v[52:55], a[92:95], v[100:103]
  ds_read_b64_tr_b16 v[52:53], v17 offset:3616
  ds_read_b64_tr_b16 v[54:55], v17 offset:3728
  s_cmp_eq_u32 s93, 0
  s_cbranch_scc1 L_g18
  s_waitcnt lgkmcnt(4)
  s_cmp_eq_u32 s93, 1
  s_cbranch_scc1 L_g18a
  v_mfma_f32_16x16x32_bf16 v[104:107], v[128:131], a[92:95], v[104:107]
  s_branch L_g18b
L_g18a:
  v_mfma_f32_16x16x32_bf16 v[104:107], v[128:131], a[36:39], v[104:107]
L_g18b:
  ds_read_b128 v[124:127], v20 offset:640
L_g18:
  s_waitcnt lgkmcnt(6)
  v_mfma_f32_16x16x32_bf16 v[88:91], v[40:43], a[40:43], v[88:91]
  v_mfma_f32_16x16x32_bf16 v[96:99], v[40:43], a[96:99], v[96:99]
  ds_read_b64_tr_b16 v[40:41], v17 offset:7168
  ds_read_b64_tr_b16 v[42:43], v17 offset:7280
  s_add_u32 m0, s85, 0
  s_nop 0
  buffer_load_dwordx4 v16, s[16:19], s84 offen lds
  s_add_u32 s85, s85, 8192
  s_cmp_ge_u32 s85, 57344
  s_cselect_b32 s83, 57344, 0
  s_sub_u32 s85, s85, s83
  s_mul_i32 s84, s85, 7
  s_waitcnt lgkmcnt(6)
  v_mfma_f32_16x16x32_bf16 v[92:95], v[44:47], a[40:43], v[92:95]
  v_mfma_f32_16x16x32_bf16 v[100:103], v[44:47], a[96:99], v[100:103]
  ds_read_b64_tr_b16 v[44:45], v17 offset:7200
  ds_read_b64_tr_b16 v[46:47], v17 offset:7312
  s_cmp_eq_u32 s93, 0
  s_cbranch_scc1 L_g19
  s_waitcnt lgkmcnt(4)
  s_cmp_eq_u32 s93, 1
  s_cbranch_scc1 L_g19a
  v_mfma_f32_16x16x32_bf16 v[104:107], v[124:127], a[96:99], v[104:107]
  s_branch L_g19b
L_g19a:
  v_mfma_f32_16x16x32_bf16 v[104:107], v[124:127], a[40:43], v[104:107]
L_g19b:
  ds_read_b128 v[128:131], v20 offset:704
L_g19:
  s_waitcnt lgkmcnt(6)
  v_mfma_f32_16x16x32_bf16 v[88:91], v[48:51], a[44:47], v[88:91]
  v_mfma_f32_16x16x32_bf16 v[96:99], v[48:51], a[100:103], v[96:99]
  ds_read_b64_tr_b16 v[48:49], v17 offset:10752
  ds_read_b64_tr_b16 v[50:51], v17 offset:10864
  s_add_u32 m0, s85, 0
  s_nop 0
  buffer_load_dwordx4 v16, s[16:19], s84 offen lds
  s_add_u32 s85, s85, 8192
  s_cmp_ge_u32 s85, 57344
  s_cselect_b32 s83, 57344, 0
  s_sub_u32 s85, s85, s83
  s_mul_i32 s84, s85, 7
  s_waitcnt lgkmcnt(6)
  v_mfma_f32_16x16x32_bf16 v[92:95], v[52:55], a[44:47], v[92:95]
  v_mfma_f32_16x16x32_bf16 v[100:103], v[52:55], a[100:103], v[100:103]
  ds_read_b64_tr_b16 v[52:53], v17 offset:10784
  ds_read_b64_tr_b16 v[54:55], v17 offset:10896
  s_cmp_eq_u32 s93, 0
  s_cbranch_scc1 L_g20
  s_waitcnt lgkmcnt(4)
  s_cmp_eq_u32 s93, 1
  s_cbranch_scc1 L_g20a
  v_mfma_f32_16x16x32_bf16 v[104:107], v[128:131], a[100:103], v[104:107]
  s_branch L_g20b
L_g20a:
  v_mfma_f32_16x16x32_bf16 v[104:107], v[128:131], a[44:47], v[104:107]
L_g20b:
  ds_read_b128 v[124:127], v20 offset:768
L_g20:
  s_waitcnt lgkmcnt(6)
  v_mfma_f32_16x16x32_bf16 v[88:91], v[40:43], a[48:51], v[88:91]
  v_mfma_f32_16x16x32_bf16 v[96:99], v[40:43], a[104:107], v[96:99]
  s_waitcnt lgkmcnt(4)
  v_mfma_f32_16x16x32_bf16 v[92:95], v[44:47], a[48:51], v[92:95]
  v_mfma_f32_16x16x32_bf16 v[100:103], v[44:47], a[104:107], v[100:103]
  s_cmp_eq_u32 s93, 0
  s_cbranch_scc1 L_g21
  s_waitcnt lgkmcnt(0)
  s_cmp_eq_u32 s93, 1
  s_cbranch_scc1 L_g21a
  v_mfma_f32_16x16x32_bf16 v[104:107], v[124:127], a[104:107], v[104:107]
  s_branch L_g21b
L_g21a:
  v_mfma_f32_16x16x32_bf16 v[104:107], v[124:127], a[48:51], v[104:107]
L_g21b:
  ds_read_b128 v[128:131], v20 offset:832
L_g21:
  s_waitcnt lgkmcnt(2)
  v_mfma_f32_16x16x32_bf16 v[88:91], v[48:51], a[52:55], v[88:91]
  v_mfma_f32_16x16x32_bf16 v[96:99], v[48:51], a[108:111], v[96:99]
  s_waitcnt lgkmcnt(0)
  v_mfma_f32_16x16x32_bf16 v[92:95], v[52:55], a[52:55], v[92:95]
  v_mfma_f32_16x16x32_bf16 v[100:103], v[52:55], a[108:111], v[100:103]
  s_cmp_eq_u32 s93, 0
  s_cbranch_scc1 L_g22
  s_waitcnt lgkmcnt(0)
  s_cmp_eq_u32 s93, 1
  s_cbranch_scc1 L_g22a
  v_mfma_f32_16x16x32_bf16 v[104:107], v[128:131], a[108:111], v[104:107]
  s_branch L_g22b
L_g22a:
  v_mfma_f32_16x16x32_bf16 v[104:107], v[128:131], a[52:55], v[104:107]
L_g22b:
L_g22:
  v_mul_f32 v2, s98, v88
  v_mul_f32 v3, s98, v89
  v_mul_f32 v4, s98, v90
  v_mul_f32 v5, s98, v91
  v_exp_f32 v2, -|v2|
  v_exp_f32 v3, -|v3|
  v_exp_f32 v4, -|v4|
  v_exp_f32 v5, -|v5|
  v_add_f32 v88, 1.0, v88
  v_add_f32 v89, 1.0, v89
  v_add_f32 v90, 1.0, v90
  v_add_f32 v91, 1.0, v91
  v_max_f32 v88, v88, v2
  v_max_f32 v89, v89, v3
  v_max_f32 v90, v90, v4
  v_max_f32 v91, v91, v5
  v_add_f32 v88, s99, v88
  v_add_f32 v89, s99, v89
  v_add_f32 v90, s99, v90
  v_add_f32 v91, s99, v91
  v_mul_f32 v6, s98, v92
  v_mul_f32 v7, s98, v93
  v_mul_f32 v8, s98, v94
  v_mul_f32 v9, s98, v95
  v_exp_f32 v6, -|v6|
  v_exp_f32 v7, -|v7|
  v_exp_f32 v8, -|v8|
  v_exp_f32 v9, -|v9|
  v_add_f32 v92, 1.0, v92
  v_add_f32 v93, 1.0, v93
  v_add_f32 v94, 1.0, v94
  v_add_f32 v95, 1.0, v95
  v_max_f32 v92, v92, v6
  v_max_f32 v93, v93, v7
  v_max_f32 v94, v94, v8
  v_max_f32 v95, v95, v9
  v_add_f32 v92, s99, v92
  v_add_f32 v93, s99, v93
  v_add_f32 v94, s99, v94
  v_add_f32 v95, s99, v95
  v_cvt_pk_bf16_f32 v40, v88, v89
  v_cvt_pk_bf16_f32 v41, v90, v91
  v_cvt_pk_bf16_f32 v42, v92, v93
  v_cvt_pk_bf16_f32 v43, v94, v95
  v_and_b32 v42, v34, v42
  v_and_b32 v43, v34, v43
  s_waitcnt vmcnt(0)
  s_cmp_lg_u32 s59, 1
  s_cbranch_scc1 L_kvwait_d
  s_mov_b64 exec, 1
  s_mov_b32 s3, 0
L_kvwait:
  buffer_load_dword v36, off, s[12:15], s92 sc1
  s_add_u32 s3, s3, 1
  s_waitcnt vmcnt(0)
  v_readfirstlane_b32 s89, v36
  s_nop 1
  s_cmp_ge_u32 s89, 16
  s_cbranch_scc1 L_kvwait_k
  s_cmp_ge_u32 s3, 524288
  s_cbranch_scc1 L_kvwait_k
  s_sleep 1
  s_branch L_kvwait
L_kvwait_k:
  s_mov_b64 exec, -1
L_kvwait_d:
  s_barrier
  s_lshl_b32 s87, s58, 13
  s_lshl_b32 s88, s63, 12
  s_add_u32 s87, s87, s88
  s_add_u32 s87, s87, 4194304
  buffer_load_dwordx4 v[56:59], v35, s[12:15], s87 offen offset:0 sc1
  buffer_load_dwordx4 v[60:63], v35, s[12:15], s87 offen offset:1024 sc1
  buffer_load_dwordx4 v[64:67], v35, s[12:15], s87 offen offset:2048 sc1
  buffer_load_dwordx4 v[68:71], v35, s[12:15], s87 offen offset:3072 sc1
  v_mul_f32 v2, s98, v96
  v_mul_f32 v3, s98, v97
  v_mul_f32 v4, s98, v98
  v_mul_f32 v5, s98, v99
  v_exp_f32 v2, -|v2|
  v_exp_f32 v3, -|v3|
  v_exp_f32 v4, -|v4|
  v_exp_f32 v5, -|v5|
  v_add_f32 v96, 1.0, v96
  v_add_f32 v97, 1.0, v97
  v_add_f32 v98, 1.0, v98
  v_add_f32 v99, 1.0, v99
  v_max_f32 v96, v96, v2
  v_max_f32 v97, v97, v3
  v_max_f32 v98, v98, v4
  v_max_f32 v99, v99, v5
  v_add_f32 v96, s99, v96
  v_add_f32 v97, s99, v97
  v_add_f32 v98, s99, v98
  v_add_f32 v99, s99, v99
  v_mul_f32 v6, s98, v100
  v_mul_f32 v7, s98, v101
  v_mul_f32 v8, s98, v102
  v_mul_f32 v9, s98, v103
  v_exp_f32 v6, -|v6|
  v_exp_f32 v7, -|v7|
  v_exp_f32 v8, -|v8|
  v_exp_f32 v9, -|v9|
  v_add_f32 v100, 1.0, v100
  v_add_f32 v101, 1.0, v101
  v_add_f32 v102, 1.0, v102
  v_add_f32 v103, 1.0, v103
  v_max_f32 v100, v100, v6
  v_max_f32 v101, v101, v7
  v_max_f32 v102, v102, v8
  v_max_f32 v103, v103, v9
  v_add_f32 v100, s99, v100
  v_add_f32 v101, s99, v101
  v_add_f32 v102, s99, v102
  v_add_f32 v103, s99, v103
  v_cvt_pk_bf16_f32 v44, v96, v97
  v_cvt_pk_bf16_f32 v45, v98, v99
  v_cvt_pk_bf16_f32 v46, v100, v101
  v_cvt_pk_bf16_f32 v47, v102, v103
  v_and_b32 v46, v34, v46
  v_and_b32 v47, v34, v47
  v_lshlrev_b32 v37, 2, v1
  s_cmp_eq_u32 s93, 0
  s_cbranch_scc1 L_nog
  v_mul_f32 v104, s98, v104
  v_exp_f32 v104, -v104
  s_lshl_b32 s86, s57, 3
  v_add_f32 v104, 1.0, v104
  s_add_u32 s86, s86, s58
  v_rcp_f32 v104, v104
  s_lshl_b32 s86, s86, 6
  s_add_u32 s86, s86, 4325376
  s_mov_b64 exec, 0xffff
  buffer_store_dword v104, v37, s[12:15], s86 offen sc1
  s_mov_b64 exec, -1
L_nog:
  s_lshl_b32 s86, s57, 3
  s_and_b32 s87, s59, 5
  s_add_u32 s86, s86, s87
  s_lshl_b32 s86, s86, 5
  s_lshl_b32 s87, s56, 4
  s_add_u32 s86, s86, s87
  s_lshl_b32 s87, s58, 1
  s_add_u32 s86, s86, s87
  s_add_u32 s86, s86, s63
  s_lshl_b32 s94, s86, 10
  s_add_u32 s95, s94, 65536
  s_waitcnt vmcnt(3)
  v_cvt_pk_bf16_f32 v48, v56, v57
  v_cvt_pk_bf16_f32 v49, v58, v59
  s_waitcnt vmcnt(2)
  v_cvt_pk_bf16_f32 v50, v60, v61
  v_cvt_pk_bf16_f32 v51, v62, v63
  s_waitcnt vmcnt(1)
  v_cvt_pk_bf16_f32 v52, v64, v65
  v_cvt_pk_bf16_f32 v53, v66, v67
  s_waitcnt vmcnt(0)
  v_cvt_pk_bf16_f32 v54, v68, v69
  v_cvt_pk_bf16_f32 v55, v70, v71
  v_mov_b32_dpp v108, v52 row_newbcast:12 row_mask:0xf bank_mask:0xf
  v_mov_b32_dpp v109, v53 row_newbcast:12 row_mask:0xf bank_mask:0xf
  v_mov_b32_dpp v110, v54 row_newbcast:12 row_mask:0xf bank_mask:0xf
  v_mov_b32_dpp v111, v55 row_newbcast:12 row_mask:0xf bank_mask:0xf
  s_nop 1
  v_mfma_f32_16x16x32_bf16 v[112:115], v[108:111], v[40:43], 0
  v_mfma_f32_16x16x32_bf16 v[72:75], v[48:51], v[40:43], 0
  v_mfma_f32_16x16x32_bf16 v[76:79], v[52:55], v[40:43], 0
  v_mfma_f32_16x16x32_bf16 v[116:119], v[108:111], v[44:47], 0
  v_mfma_f32_16x16x32_bf16 v[80:83], v[48:51], v[44:47], 0
  v_mfma_f32_16x16x32_bf16 v[84:87], v[52:55], v[44:47], 0
  s_nop 2
  v_add_f32 v112, s99, v112
  v_rcp_f32 v112, v112
  s_nop 0
  v_mul_f32 v72, v112, v72
  v_mul_f32 v73, v112, v73
  v_mul_f32 v74, v112, v74
  v_mul_f32 v75, v112, v75
  v_cvt_pk_bf16_f32 v120, v72, v73
  v_cvt_pk_bf16_f32 v121, v74, v75
  v_mul_f32 v76, v112, v76
  v_mul_f32 v77, v112, v77
  v_mul_f32 v78, v112, v78
  v_mul_f32 v79, v112, v79
  v_cvt_pk_bf16_f32 v122, v76, v77
  v_cvt_pk_bf16_f32 v123, v78, v79
  v_and_b32 v122, v34, v122
  v_and_b32 v123, v34, v123
  buffer_store_dwordx4 v[120:123], v35, s[12:15], s94 offen sc1
  v_add_f32 v116, s99, v116
  v_rcp_f32 v116, v116
  s_nop 0
  v_mul_f32 v80, v116, v80
  v_mul_f32 v81, v116, v81
  v_mul_f32 v82, v116, v82
  v_mul_f32 v83, v116, v83
  v_cvt_pk_bf16_f32 v124, v80, v81
  v_cvt_pk_bf16_f32 v125, v82, v83
  v_mul_f32 v84, v116, v84
  v_mul_f32 v85, v116, v85
  v_mul_f32 v86, v116, v86
  v_mul_f32 v87, v116, v87
  v_cvt_pk_bf16_f32 v126, v84, v85
  v_cvt_pk_bf16_f32 v127, v86, v87
  v_and_b32 v126, v34, v126
  v_and_b32 v127, v34, v127
  buffer_store_dwordx4 v[124:127], v35, s[12:15], s95 offen sc1
L_publish:
  s_nop 1
  s_lshr_b32 s86, s57, 1
  s_lshl_b32 s86, s86, 10
  s_and_b32 s87, s57, 1
  s_lshl_b32 s88, s56, 1
  s_add_u32 s87, s87, s88
  s_lshl_b32 s87, s87, 7
  s_add_u32 s82, s86, s87
  s_add_u32 s82, s82, 4259968
  s_and_b32 s86, s78, 3
  s_and_b32 s64, s2, 7
  s_lshl_b32 s64, s64, 2
  s_add_u32 s64, s64, s86
  s_lshr_b32 s65, s78, 2
  s_lshl_b32 s65, s65, 1
  v_lshrrev_b32 v3, 4, v1
  v_bfe_u32 v4, v1, 2, 2
  v_lshl_add_u32 v5, v3, 2, v4
  v_bfe_u32 v6, v5, 1, 2
  v_lshlrev_b32 v5, 7, v5
  v_and_b32 v7, 3, v1
  v_lshl_add_u32 v5, v7, 3, v5
  v_xor_b32 v7, 0, v6
  v_lshl_add_u32 v10, v7, 5, v5
  v_xor_b32 v7, 1, v6
  v_lshl_add_u32 v11, v7, 5, v5
  v_xor_b32 v7, 2, v6
  v_lshl_add_u32 v12, v7, 5, v5
  v_xor_b32 v7, 3, v6
  v_lshl_add_u32 v13, v7, 5, v5
  s_and_b32 s89, s59, 3
  v_and_b32 v7, 15, v1
  s_lshl_b32 s86, s89, 11
  s_add_u32 s86, s86, 118784
  v_lshrrev_b32 v8, 1, v3
  v_and_b32 v9, 7, v7
  v_xor_b32 v8, v8, v9
  v_lshlrev_b32 v8, 4, v8
  v_lshl_add_u32 v8, v7, 7, v8
  v_and_b32 v9, 1, v3
  v_lshl_add_u32 v8, v9, 3, v8
  v_add_u32 v24, s86, v8
  v_lshrrev_b32 v8, 3, v1
  v_and_b32 v9, 7, v1
  v_xor_b32 v6, v9, v8
  v_lshlrev_b32 v6, 4, v6
  v_lshl_add_u32 v6, v8, 7, v6
  v_add_u32 v25, s86, v6
  s_lshl_b32 s86, s89, 12
  s_add_u32 s86, s86, 131072
  v_add_u32 v26, s86, v35
  s_lshl_b32 s86, s64, 6
  s_lshl_b32 s87, s63, 5
  s_add_u32 s86, s86, s87
  s_add_u32 s86, s86, s61
  v_lshl_add_u32 v8, v8, 1, s86
  v_mul_u32_u24 v8, 896, v8
  v_lshl_add_u32 v22, v9, 4, v8
  s_lshl_b32 s87, s65, 6
  v_add_u32 v22, s87, v22
  v_lshlrev_b32 v23, 2, v7
  s_lshr_b32 s86, s64, 2
  s_lshl_b32 s86, s86, 10
  s_bfe_u32 s87, s64, 0x10001
  s_lshl_b32 s87, s87, 7
  s_add_u32 s66, s86, s87
  s_add_u32 s66, s66, 4259968
  s_lshl_b32 s68, s64, 2
  s_add_u32 s68, s68, s89
  s_lshl_b32 s88, s68, 6
  s_add_u32 s88, s88, 4325376
  v_add_u32 v23, s88, v23
  s_lshl_b32 s68, s68, 15
  s_lshl_b32 s87, s62, 3
  s_add_u32 s65, s65, s87
  s_add_u32 s69, s66, 256
  s_cmp_eq_u32 s56, 0
  s_cbranch_scc1 L_pubA
  s_add_u32 s88, s65, 0
  s_and_b32 s88, s88, 15
  s_mul_i32 s88, s88, 3584
  v_add_u32 v18, s88, v10
  v_add_u32 v19, s88, v11
  v_add_u32 v20, s88, v12
  v_add_u32 v21, s88, v13
  ds_read_b64_tr_b16 a[32:33], v18
  ds_read_b64_tr_b16 a[34:35], v18 offset:2048
  ds_read_b64_tr_b16 a[36:37], v19
  ds_read_b64_tr_b16 a[38:39], v19 offset:2048
  ds_read_b64_tr_b16 a[40:41], v20
  ds_read_b64_tr_b16 a[42:43], v20 offset:2048
  ds_read_b64_tr_b16 a[44:45], v21
  ds_read_b64_tr_b16 a[46:47], v21 offset:2048
  s_add_u32 s88, s65, 1
  s_and_b32 s88, s88, 15
  s_mul_i32 s88, s88, 3584
  v_add_u32 v18, s88, v12
  v_add_u32 v19, s88, v13
  v_add_u32 v20, s88, v10
  v_add_u32 v21, s88, v11
  ds_read_b64_tr_b16 a[48:49], v18
  ds_read_b64_tr_b16 a[50:51], v18 offset:2048
  ds_read_b64_tr_b16 a[52:53], v19
  ds_read_b64_tr_b16 a[54:55], v19 offset:2048
  ds_read_b64_tr_b16 a[56:57], v20
  ds_read_b64_tr_b16 a[58:59], v20 offset:2048
  ds_read_b64_tr_b16 a[60:61], v21
  ds_read_b64_tr_b16 a[62:63], v21 offset:2048
  s_add_u32 s88, s65, 2
  s_and_b32 s88, s88, 15
  s_mul_i32 s88, s88, 3584
  v_add_u32 v18, s88, v10
  v_add_u32 v19, s88, v11
  v_add_u32 v20, s88, v12
  v_add_u32 v21, s88, v13
  ds_read_b64_tr_b16 a[64:65], v18
  ds_read_b64_tr_b16 a[66:67], v18 offset:2048
  ds_read_b64_tr_b16 a[68:69], v19
  ds_read_b64_tr_b16 a[70:71], v19 offset:2048
  ds_read_b64_tr_b16 a[72:73], v20
  ds_read_b64_tr_b16 a[74:75], v20 offset:2048
  ds_read_b64_tr_b16 a[76:77], v21
  ds_read_b64_tr_b16 a[78:79], v21 offset:2048
  s_add_u32 s88, s65, 3
  s_and_b32 s88, s88, 15
  s_mul_i32 s88, s88, 3584
  v_add_u32 v18, s88, v12
  v_add_u32 v19, s88, v13
  v_add_u32 v20, s88, v10
  v_add_u32 v21, s88, v11
  ds_read_b64_tr_b16 a[80:81], v18
  ds_read_b64_tr_b16 a[82:83], v18 offset:2048
  ds_read_b64_tr_b16 a[84:85], v19
  ds_read_b64_tr_b16 a[86:87], v19 offset:2048
  ds_read_b64_tr_b16 a[88:89], v20
  ds_read_b64_tr_b16 a[90:91], v20 offset:2048
  ds_read_b64_tr_b16 a[92:93], v21
  ds_read_b64_tr_b16 a[94:95], v21 offset:2048
  s_add_u32 s88, s65, 4
  s_and_b32 s88, s88, 15
  s_mul_i32 s88, s88, 3584
  v_add_u32 v18, s88, v10
  v_add_u32 v19, s88, v11
  v_add_u32 v20, s88, v12
  v_add_u32 v21, s88, v13
  ds_read_b64_tr_b16 a[96:97], v18
  ds_read_b64_tr_b16 a[98:99], v18 offset:2048
  ds_read_b64_tr_b16 a[100:101], v19
  ds_read_b64_tr_b16 a[102:103], v19 offset:2048
  ds_read_b64_tr_b16 a[104:105], v20
  ds_read_b64_tr_b16 a[106:107], v20 offset:2048
  ds_read_b64_tr_b16 a[108:109], v21
  ds_read_b64_tr_b16 a[110:111], v21 offset:2048
  s_add_u32 s88, s65, 5
  s_and_b32 s88, s88, 15
  s_mul_i32 s88, s88, 3584
  v_add_u32 v18, s88, v12
  v_add_u32 v19, s88, v13
  v_add_u32 v20, s88, v10
  v_add_u32 v21, s88, v11
  ds_read_b64_tr_b16 v[56:57], v18
  ds_read_b64_tr_b16 v[58:59], v18 offset:2048
  ds_read_b64_tr_b16 v[60:61], v19
  ds_read_b64_tr_b16 v[62:63], v19 offset:2048
  ds_read_b64_tr_b16 v[64:65], v20
  ds_read_b64_tr_b16 v[66:67], v20 offset:2048
  ds_read_b64_tr_b16 v[68:69], v21
  ds_read_b64_tr_b16 v[70:71], v21 offset:2048
  s_add_u32 s88, s65, 6
  s_and_b32 s88, s88, 15
  s_mul_i32 s88, s88, 3584
  v_add_u32 v18, s88, v10
  v_add_u32 v19, s88, v11
  v_add_u32 v20, s88, v12
  v_add_u32 v21, s88, v13
  ds_read_b64_tr_b16 v[72:73], v18
  ds_read_b64_tr_b16 v[74:75], v18 offset:2048
  ds_read_b64_tr_b16 v[76:77], v19
  ds_read_b64_tr_b16 v[78:79], v19 offset:2048
  ds_read_b64_tr_b16 v[80:81], v20
  ds_read_b64_tr_b16 v[82:83], v20 offset:2048
  ds_read_b64_tr_b16 v[84:85], v21
  ds_read_b64_tr_b16 v[86:87], v21 offset:2048
  s_add_u32 s88, s65, 7
  s_and_b32 s88, s88, 15
  s_mul_i32 s88, s88, 3584
  v_add_u32 v18, s88, v12
  v_add_u32 v19, s88, v13
  v_add_u32 v20, s88, v10
  v_add_u32 v21, s88, v11
  ds_read_b64_tr_b16 v[88:89], v18
  ds_read_b64_tr_b16 v[90:91], v18 offset:2048
  ds_read_b64_tr_b16 v[92:93], v19
  ds_read_b64_tr_b16 v[94:95], v19 offset:2048
  ds_read_b64_tr_b16 v[96:97], v20
  ds_read_b64_tr_b16 v[98:99], v20 offset:2048
  ds_read_b64_tr_b16 v[100:101], v21
  ds_read_b64_tr_b16 v[102:103], v21 offset:2048
  s_waitcnt vmcnt(0)
  s_barrier
  s_cmp_lg_u32 s59, 0
  s_cbranch_scc1 L_oaddB
  v_mov_b32 v36, 1
  s_mov_b64 exec, 1
  buffer_atomic_add v36, off, s[12:15], s82
  s_mov_b64 exec, -1
L_oaddB:
  s_cmp_ge_u32 s78, 28
  s_cbranch_scc1 L_fin
  s_branch L_p2
L_pubA:
  s_waitcnt vmcnt(0)
  s_waitcnt lgkmcnt(0)
  s_barrier
  s_cmp_lg_u32 s59, 0
  s_cbranch_scc1 L_oaddA
  v_mov_b32 v36, 1
  s_mov_b64 exec, 1
  buffer_atomic_add v36, off, s[12:15], s82
  s_mov_b64 exec, -1
L_oaddA:
  s_cmp_ge_u32 s78, 28
  s_cbranch_scc1 L_fin
  s_add_u32 m0, s85, 0
  s_nop 0
  buffer_load_dwordx4 v16, s[16:19], s84 offen lds
  s_add_u32 s85, s85, 8192
  s_cmp_ge_u32 s85, 57344
  s_cselect_b32 s83, 57344, 0
  s_sub_u32 s85, s85, s83
  s_mul_i32 s84, s85, 7
  s_add_u32 m0, s85, 0
  s_nop 0
  buffer_load_dwordx4 v16, s[16:19], s84 offen lds
  s_add_u32 s85, s85, 8192
  s_cmp_ge_u32 s85, 57344
  s_cselect_b32 s83, 57344, 0
  s_sub_u32 s85, s85, s83
  s_mul_i32 s84, s85, 7
  s_add_u32 m0, s85, 0
  s_nop 0
  buffer_load_dwordx4 v16, s[16:19], s84 offen lds
  s_add_u32 s85, s85, 8192
  s_cmp_ge_u32 s85, 57344
  s_cselect_b32 s83, 57344, 0
  s_sub_u32 s85, s85, s83
  s_mul_i32 s84, s85, 7
  s_add_u32 m0, s85, 0
  s_nop 0
  buffer_load_dwordx4 v16, s[16:19], s84 offen lds
  s_add_u32 s85, s85, 8192
  s_cmp_ge_u32 s85, 57344
  s_cselect_b32 s83, 57344, 0
  s_sub_u32 s85, s85, s83
  s_mul_i32 s84, s85, 7
  s_add_u32 m0, s85, 0
  s_nop 0
  buffer_load_dwordx4 v16, s[16:19], s84 offen lds
  s_add_u32 s85, s85, 8192
  s_cmp_ge_u32 s85, 57344
  s_cselect_b32 s83, 57344, 0
  s_sub_u32 s85, s85, s83
  s_mul_i32 s84, s85, 7
  s_add_u32 m0, s85, 0
  s_nop 0
  buffer_load_dwordx4 v16, s[16:19], s84 offen lds
  s_add_u32 s85, s85, 8192
  s_cmp_ge_u32 s85, 57344
  s_cselect_b32 s83, 57344, 0
  s_sub_u32 s85, s85, s83
  s_mul_i32 s84, s85, 7
  s_add_u32 m0, s85, 0
  s_nop 0
  buffer_load_dwordx4 v16, s[16:19], s84 offen lds
  s_add_u32 s85, s85, 8192
  s_cmp_ge_u32 s85, 57344
  s_cselect_b32 s83, 57344, 0
  s_sub_u32 s85, s85, s83
  s_mul_i32 s84, s85, 7
  s_waitcnt vmcnt(0)
  s_barrier
  s_add_u32 s88, s65, 0
  s_and_b32 s88, s88, 15
  s_mul_i32 s88, s88, 3584
  v_add_u32 v18, s88, v10
  v_add_u32 v19, s88, v11
  v_add_u32 v20, s88, v12
  v_add_u32 v21, s88, v13
  ds_read_b64_tr_b16 a[32:33], v18
  ds_read_b64_tr_b16 a[34:35], v18 offset:2048
  ds_read_b64_tr_b16 a[36:37], v19
  ds_read_b64_tr_b16 a[38:39], v19 offset:2048
  ds_read_b64_tr_b16 a[40:41], v20
  ds_read_b64_tr_b16 a[42:43], v20 offset:2048
  ds_read_b64_tr_b16 a[44:45], v21
  ds_read_b64_tr_b16 a[46:47], v21 offset:2048
  s_add_u32 s88, s65, 1
  s_and_b32 s88, s88, 15
  s_mul_i32 s88, s88, 3584
  v_add_u32 v18, s88, v12
  v_add_u32 v19, s88, v13
  v_add_u32 v20, s88, v10
  v_add_u32 v21, s88, v11
  ds_read_b64_tr_b16 a[48:49], v18
  ds_read_b64_tr_b16 a[50:51], v18 offset:2048
  ds_read_b64_tr_b16 a[52:53], v19
  ds_read_b64_tr_b16 a[54:55], v19 offset:2048
  ds_read_b64_tr_b16 a[56:57], v20
  ds_read_b64_tr_b16 a[58:59], v20 offset:2048
  ds_read_b64_tr_b16 a[60:61], v21
  ds_read_b64_tr_b16 a[62:63], v21 offset:2048
  s_add_u32 s88, s65, 2
  s_and_b32 s88, s88, 15
  s_mul_i32 s88, s88, 3584
  v_add_u32 v18, s88, v10
  v_add_u32 v19, s88, v11
  v_add_u32 v20, s88, v12
  v_add_u32 v21, s88, v13
  ds_read_b64_tr_b16 a[64:65], v18
  ds_read_b64_tr_b16 a[66:67], v18 offset:2048
  ds_read_b64_tr_b16 a[68:69], v19
  ds_read_b64_tr_b16 a[70:71], v19 offset:2048
  ds_read_b64_tr_b16 a[72:73], v20
  ds_read_b64_tr_b16 a[74:75], v20 offset:2048
  ds_read_b64_tr_b16 a[76:77], v21
  ds_read_b64_tr_b16 a[78:79], v21 offset:2048
  s_add_u32 s88, s65, 3
  s_and_b32 s88, s88, 15
  s_mul_i32 s88, s88, 3584
  v_add_u32 v18, s88, v12
  v_add_u32 v19, s88, v13
  v_add_u32 v20, s88, v10
  v_add_u32 v21, s88, v11
  ds_read_b64_tr_b16 a[80:81], v18
  ds_read_b64_tr_b16 a[82:83], v18 offset:2048
  ds_read_b64_tr_b16 a[84:85], v19
  ds_read_b64_tr_b16 a[86:87], v19 offset:2048
  ds_read_b64_tr_b16 a[88:89], v20
  ds_read_b64_tr_b16 a[90:91], v20 offset:2048
  ds_read_b64_tr_b16 a[92:93], v21
  ds_read_b64_tr_b16 a[94:95], v21 offset:2048
  s_add_u32 s88, s65, 4
  s_and_b32 s88, s88, 15
  s_mul_i32 s88, s88, 3584
  v_add_u32 v18, s88, v10
  v_add_u32 v19, s88, v11
  v_add_u32 v20, s88, v12
  v_add_u32 v21, s88, v13
  ds_read_b64_tr_b16 a[96:97], v18
  ds_read_b64_tr_b16 a[98:99], v18 offset:2048
  ds_read_b64_tr_b16 a[100:101], v19
  ds_read_b64_tr_b16 a[102:103], v19 offset:2048
  ds_read_b64_tr_b16 a[104:105], v20
  ds_read_b64_tr_b16 a[106:107], v20 offset:2048
  ds_read_b64_tr_b16 a[108:109], v21
  ds_read_b64_tr_b16 a[110:111], v21 offset:2048
  s_add_u32 s88, s65, 5
  s_and_b32 s88, s88, 15
  s_mul_i32 s88, s88, 3584
  v_add_u32 v18, s88, v12
  v_add_u32 v19, s88, v13
  v_add_u32 v20, s88, v10
  v_add_u32 v21, s88, v11
  ds_read_b64_tr_b16 v[56:57], v18
  ds_read_b64_tr_b16 v[58:59], v18 offset:2048
  ds_read_b64_tr_b16 v[60:61], v19
  ds_read_b64_tr_b16 v[62:63], v19 offset:2048
  ds_read_b64_tr_b16 v[64:65], v20
  ds_read_b64_tr_b16 v[66:67], v20 offset:2048
  ds_read_b64_tr_b16 v[68:69], v21
  ds_read_b64_tr_b16 v[70:71], v21 offset:2048
  s_add_u32 s88, s65, 6
  s_and_b32 s88, s88, 15
  s_mul_i32 s88, s88, 3584
  v_add_u32 v18, s88, v10
  v_add_u32 v19, s88, v11
  v_add_u32 v20, s88, v12
  v_add_u32 v21, s88, v13
  ds_read_b64_tr_b16 v[72:73], v18
  ds_read_b64_tr_b16 v[74:75], v18 offset:2048
  ds_read_b64_tr_b16 v[76:77], v19
  ds_read_b64_tr_b16 v[78:79], v19 offset:2048
  ds_read_b64_tr_b16 v[80:81], v20
  ds_read_b64_tr_b16 v[82:83], v20 offset:2048
  ds_read_b64_tr_b16 v[84:85], v21
  ds_read_b64_tr_b16 v[86:87], v21 offset:2048
  s_add_u32 s88, s65, 7
  s_and_b32 s88, s88, 15
  s_mul_i32 s88, s88, 3584
  v_add_u32 v18, s88, v12
  v_add_u32 v19, s88, v13
  v_add_u32 v20, s88, v10
  v_add_u32 v21, s88, v11
  ds_read_b64_tr_b16 v[88:89], v18
  ds_read_b64_tr_b16 v[90:91], v18 offset:2048
  ds_read_b64_tr_b16 v[92:93], v19
  ds_read_b64_tr_b16 v[94:95], v19 offset:2048
  ds_read_b64_tr_b16 v[96:97], v20
  ds_read_b64_tr_b16 v[98:99], v20 offset:2048
  ds_read_b64_tr_b16 v[100:101], v21
  ds_read_b64_tr_b16 v[102:103], v21 offset:2048
L_p2:
  s_cmp_lg_u32 s59, 1
  s_cbranch_scc1 L_wait0_d
  s_mov_b64 exec, 1
  s_mov_b32 s3, 0
L_wait0:
  buffer_load_dword v36, off, s[12:15], s66 sc1
  s_add_u32 s3, s3, 1
  s_waitcnt vmcnt(0)
  v_readfirstlane_b32 s89, v36
  s_nop 1
  s_cmp_ge_u32 s89, 8
  s_cbranch_scc1 L_wait0_k
  s_cmp_ge_u32 s3, 524288
  s_cbranch_scc1 L_wait0_k
  s_sleep 1
  s_branch L_wait0
L_wait0_k:
  s_mov_b64 exec, -1
L_wait0_d:
  s_barrier
  s_add_u32 s87, s65, 0
  s_and_b32 s87, s87, 15
  s_lshl_b32 s87, s87, 10
  s_add_u32 s87, s87, s68
  buffer_load_dwordx4 a[0:3], v35, s[12:15], s87 offen offset:0 sc1
  s_add_u32 s87, s65, 1
  s_and_b32 s87, s87, 15
  s_lshl_b32 s87, s87, 10
  s_add_u32 s87, s87, s68
  buffer_load_dwordx4 a[4:7], v35, s[12:15], s87 offen offset:0 sc1
  s_add_u32 s87, s65, 2
  s_and_b32 s87, s87, 15
  s_lshl_b32 s87, s87, 10
  s_add_u32 s87, s87, s68
  buffer_load_dwordx4 a[8:11], v35, s[12:15], s87 offen offset:0 sc1
  s_add_u32 s87, s65, 3
  s_and_b32 s87, s87, 15
  s_lshl_b32 s87, s87, 10
  s_add_u32 s87, s87, s68
  buffer_load_dwordx4 a[12:15], v35, s[12:15], s87 offen offset:0 sc1
  s_add_u32 s87, s65, 4
  s_and_b32 s87, s87, 15
  s_lshl_b32 s87, s87, 10
  s_add_u32 s87, s87, s68
  buffer_load_dwordx4 a[16:19], v35, s[12:15], s87 offen offset:0 sc1
  s_add_u32 s87, s65, 5
  s_and_b32 s87, s87, 15
  s_lshl_b32 s87, s87, 10
  s_add_u32 s87, s87, s68
  buffer_load_dwordx4 a[20:23], v35, s[12:15], s87 offen offset:0 sc1
  s_add_u32 s87, s65, 6
  s_and_b32 s87, s87, 15
  s_lshl_b32 s87, s87, 10
  s_add_u32 s87, s87, s68
  buffer_load_dwordx4 a[24:27], v35, s[12:15], s87 offen offset:0 sc1
  s_add_u32 s87, s65, 7
  s_and_b32 s87, s87, 15
  s_lshl_b32 s87, s87, 10
  s_add_u32 s87, s87, s68
  buffer_load_dwordx4 a[28:31], v35, s[12:15], s87 offen offset:0 sc1
  s_add_u32 s68, s68, 16384
  s_waitcnt lgkmcnt(0)
  s_waitcnt vmcnt(7)
  v_mfma_f32_16x16x32_bf16 v[104:107], a[32:35], a[0:3], 0
  v_mfma_f32_16x16x32_bf16 v[108:111], a[36:39], a[0:3], 0
  v_mfma_f32_16x16x32_bf16 v[112:115], a[40:43], a[0:3], 0
  v_mfma_f32_16x16x32_bf16 v[116:119], a[44:47], a[0:3], 0
  s_add_u32 s88, s65, 0
  s_and_b32 s88, s88, 15
  s_mul_i32 s88, s88, 3584
  s_add_u32 s88, s88, 57344
  v_add_u32 v18, s88, v10
  v_add_u32 v19, s88, v11
  v_add_u32 v20, s88, v12
  v_add_u32 v21, s88, v13
  ds_read_b64_tr_b16 a[32:33], v18
  ds_read_b64_tr_b16 a[34:35], v18 offset:2048
  ds_read_b64_tr_b16 a[36:37], v19
  ds_read_b64_tr_b16 a[38:39], v19 offset:2048
  ds_read_b64_tr_b16 a[40:41], v20
  ds_read_b64_tr_b16 a[42:43], v20 offset:2048
  ds_read_b64_tr_b16 a[44:45], v21
  ds_read_b64_tr_b16 a[46:47], v21 offset:2048
  s_waitcnt vmcnt(6)
  v_mfma_f32_16x16x32_bf16 v[104:107], a[48:51], a[4:7], v[104:107]
  v_mfma_f32_16x16x32_bf16 v[108:111], a[52:55], a[4:7], v[108:111]
  v_mfma_f32_16x16x32_bf16 v[112:115], a[56:59], a[4:7], v[112:115]
  v_mfma_f32_16x16x32_bf16 v[116:119], a[60:63], a[4:7], v[116:119]
  s_add_u32 s88, s65, 1
  s_and_b32 s88, s88, 15
  s_mul_i32 s88, s88, 3584
  s_add_u32 s88, s88, 57344
  v_add_u32 v18, s88, v12
  v_add_u32 v19, s88, v13
  v_add_u32 v20, s88, v10
  v_add_u32 v21, s88, v11
  ds_read_b64_tr_b16 a[48:49], v18
  ds_read_b64_tr_b16 a[50:51], v18 offset:2048
  ds_read_b64_tr_b16 a[52:53], v19
  ds_read_b64_tr_b16 a[54:55], v19 offset:2048
  ds_read_b64_tr_b16 a[56:57], v20
  ds_read_b64_tr_b16 a[58:59], v20 offset:2048
  ds_read_b64_tr_b16 a[60:61], v21
  ds_read_b64_tr_b16 a[62:63], v21 offset:2048
  s_waitcnt vmcnt(5)
  v_mfma_f32_16x16x32_bf16 v[104:107], a[64:67], a[8:11], v[104:107]
  v_mfma_f32_16x16x32_bf16 v[108:111], a[68:71], a[8:11], v[108:111]
  v_mfma_f32_16x16x32_bf16 v[112:115], a[72:75], a[8:11], v[112:115]
  v_mfma_f32_16x16x32_bf16 v[116:119], a[76:79], a[8:11], v[116:119]
  s_add_u32 s88, s65, 2
  s_and_b32 s88, s88, 15
  s_mul_i32 s88, s88, 3584
  s_add_u32 s88, s88, 57344
  v_add_u32 v18, s88, v10
  v_add_u32 v19, s88, v11
  v_add_u32 v20, s88, v12
  v_add_u32 v21, s88, v13
  ds_read_b64_tr_b16 a[64:65], v18
  ds_read_b64_tr_b16 a[66:67], v18 offset:2048
  ds_read_b64_tr_b16 a[68:69], v19
  ds_read_b64_tr_b16 a[70:71], v19 offset:2048
  ds_read_b64_tr_b16 a[72:73], v20
  ds_read_b64_tr_b16 a[74:75], v20 offset:2048
  ds_read_b64_tr_b16 a[76:77], v21
  ds_read_b64_tr_b16 a[78:79], v21 offset:2048
  s_waitcnt vmcnt(4)
  v_mfma_f32_16x16x32_bf16 v[104:107], a[80:83], a[12:15], v[104:107]
  v_mfma_f32_16x16x32_bf16 v[108:111], a[84:87], a[12:15], v[108:111]
  v_mfma_f32_16x16x32_bf16 v[112:115], a[88:91], a[12:15], v[112:115]
  v_mfma_f32_16x16x32_bf16 v[116:119], a[92:95], a[12:15], v[116:119]
  s_add_u32 s88, s65, 3
  s_and_b32 s88, s88, 15
  s_mul_i32 s88, s88, 3584
  s_add_u32 s88, s88, 57344
  v_add_u32 v18, s88, v12
  v_add_u32 v19, s88, v13
  v_add_u32 v20, s88, v10
  v_add_u32 v21, s88, v11
  ds_read_b64_tr_b16 a[80:81], v18
  ds_read_b64_tr_b16 a[82:83], v18 offset:2048
  ds_read_b64_tr_b16 a[84:85], v19
  ds_read_b64_tr_b16 a[86:87], v19 offset:2048
  ds_read_b64_tr_b16 a[88:89], v20
  ds_read_b64_tr_b16 a[90:91], v20 offset:2048
  ds_read_b64_tr_b16 a[92:93], v21
  ds_read_b64_tr_b16 a[94:95], v21 offset:2048
  s_waitcnt vmcnt(3)
  v_mfma_f32_16x16x32_bf16 v[104:107], a[96:99], a[16:19], v[104:107]
  v_mfma_f32_16x16x32_bf16 v[108:111], a[100:103], a[16:19], v[108:111]
  v_mfma_f32_16x16x32_bf16 v[112:115], a[104:107], a[16:19], v[112:115]
  v_mfma_f32_16x16x32_bf16 v[116:119], a[108:111], a[16:19], v[116:119]
  s_add_u32 s88, s65, 4
  s_and_b32 s88, s88, 15
  s_mul_i32 s88, s88, 3584
  s_add_u32 s88, s88, 57344
  v_add_u32 v18, s88, v10
  v_add_u32 v19, s88, v11
  v_add_u32 v20, s88, v12
  v_add_u32 v21, s88, v13
  ds_read_b64_tr_b16 a[96:97], v18
  ds_read_b64_tr_b16 a[98:99], v18 offset:2048
  ds_read_b64_tr_b16 a[100:101], v19
  ds_read_b64_tr_b16 a[102:103], v19 offset:2048
  ds_read_b64_tr_b16 a[104:105], v20
  ds_read_b64_tr_b16 a[106:107], v20 offset:2048
  ds_read_b64_tr_b16 a[108:109], v21
  ds_read_b64_tr_b16 a[110:111], v21 offset:2048
  s_waitcnt vmcnt(2)
  v_mfma_f32_16x16x32_bf16 v[104:107], v[56:59], a[20:23], v[104:107]
  v_mfma_f32_16x16x32_bf16 v[108:111], v[60:63], a[20:23], v[108:111]
  v_mfma_f32_16x16x32_bf16 v[112:115], v[64:67], a[20:23], v[112:115]
  v_mfma_f32_16x16x32_bf16 v[116:119], v[68:71], a[20:23], v[116:119]
  s_add_u32 s88, s65, 5
  s_and_b32 s88, s88, 15
  s_mul_i32 s88, s88, 3584
  s_add_u32 s88, s88, 57344
  v_add_u32 v18, s88, v12
  v_add_u32 v19, s88, v13
  v_add_u32 v20, s88, v10
  v_add_u32 v21, s88, v11
  ds_read_b64_tr_b16 v[56:57], v18
  ds_read_b64_tr_b16 v[58:59], v18 offset:2048
  ds_read_b64_tr_b16 v[60:61], v19
  ds_read_b64_tr_b16 v[62:63], v19 offset:2048
  ds_read_b64_tr_b16 v[64:65], v20
  ds_read_b64_tr_b16 v[66:67], v20 offset:2048
  ds_read_b64_tr_b16 v[68:69], v21
  ds_read_b64_tr_b16 v[70:71], v21 offset:2048
  s_waitcnt vmcnt(1)
  v_mfma_f32_16x16x32_bf16 v[104:107], v[72:75], a[24:27], v[104:107]
  v_mfma_f32_16x16x32_bf16 v[108:111], v[76:79], a[24:27], v[108:111]
  v_mfma_f32_16x16x32_bf16 v[112:115], v[80:83], a[24:27], v[112:115]
  v_mfma_f32_16x16x32_bf16 v[116:119], v[84:87], a[24:27], v[116:119]
  s_add_u32 s88, s65, 6
  s_and_b32 s88, s88, 15
  s_mul_i32 s88, s88, 3584
  s_add_u32 s88, s88, 57344
  v_add_u32 v18, s88, v10
  v_add_u32 v19, s88, v11
  v_add_u32 v20, s88, v12
  v_add_u32 v21, s88, v13
  ds_read_b64_tr_b16 v[72:73], v18
  ds_read_b64_tr_b16 v[74:75], v18 offset:2048
  ds_read_b64_tr_b16 v[76:77], v19
  ds_read_b64_tr_b16 v[78:79], v19 offset:2048
  ds_read_b64_tr_b16 v[80:81], v20
  ds_read_b64_tr_b16 v[82:83], v20 offset:2048
  ds_read_b64_tr_b16 v[84:85], v21
  ds_read_b64_tr_b16 v[86:87], v21 offset:2048
  s_waitcnt vmcnt(0)
  v_mfma_f32_16x16x32_bf16 v[104:107], v[88:91], a[28:31], v[104:107]
  v_mfma_f32_16x16x32_bf16 v[108:111], v[92:95], a[28:31], v[108:111]
  v_mfma_f32_16x16x32_bf16 v[112:115], v[96:99], a[28:31], v[112:115]
  v_mfma_f32_16x16x32_bf16 v[116:119], v[100:103], a[28:31], v[116:119]
  s_add_u32 s88, s65, 7
  s_and_b32 s88, s88, 15
  s_mul_i32 s88, s88, 3584
  s_add_u32 s88, s88, 57344
  v_add_u32 v18, s88, v12
  v_add_u32 v19, s88, v13
  v_add_u32 v20, s88, v10
  v_add_u32 v21, s88, v11
  ds_read_b64_tr_b16 v[88:89], v18
  ds_read_b64_tr_b16 v[90:91], v18 offset:2048
  ds_read_b64_tr_b16 v[92:93], v19
  ds_read_b64_tr_b16 v[94:95], v19 offset:2048
  ds_read_b64_tr_b16 v[96:97], v20
  ds_read_b64_tr_b16 v[98:99], v20 offset:2048
  ds_read_b64_tr_b16 v[100:101], v21
  ds_read_b64_tr_b16 v[102:103], v21 offset:2048
  s_cmp_lg_u32 s59, 2
  s_cbranch_scc1 L_wait1_d
  s_mov_b64 exec, 1
  s_mov_b32 s3, 0
L_wait1:
  buffer_load_dword v36, off, s[12:15], s69 sc1
  s_add_u32 s3, s3, 1
  s_waitcnt vmcnt(0)
  v_readfirstlane_b32 s89, v36
  s_nop 1
  s_cmp_ge_u32 s89, 8
  s_cbranch_scc1 L_wait1_k
  s_cmp_ge_u32 s3, 524288
  s_cbranch_scc1 L_wait1_k
  s_sleep 1
  s_branch L_wait1
L_wait1_k:
  s_mov_b64 exec, -1
L_wait1_d:
  s_barrier
  s_add_u32 s87, s65, 0
  s_and_b32 s87, s87, 15
  s_lshl_b32 s87, s87, 10
  s_add_u32 s87, s87, s68
  buffer_load_dwordx4 a[0:3], v35, s[12:15], s87 offen sc1
  s_add_u32 s87, s65, 1
  s_and_b32 s87, s87, 15
  s_lshl_b32 s87, s87, 10
  s_add_u32 s87, s87, s68
  buffer_load_dwordx4 a[4:7], v35, s[12:15], s87 offen sc1
  s_add_u32 s87, s65, 2
  s_and_b32 s87, s87, 15
  s_lshl_b32 s87, s87, 10
  s_add_u32 s87, s87, s68
  buffer_load_dwordx4 a[8:11], v35, s[12:15], s87 offen sc1
  s_add_u32 s87, s65, 3
  s_and_b32 s87, s87, 15
  s_lshl_b32 s87, s87, 10
  s_add_u32 s87, s87, s68
  buffer_load_dwordx4 a[12:15], v35, s[12:15], s87 offen sc1
  s_add_u32 s87, s65, 4
  s_and_b32 s87, s87, 15
  s_lshl_b32 s87, s87, 10
  s_add_u32 s87, s87, s68
  buffer_load_dwordx4 a[16:19], v35, s[12:15], s87 offen sc1
  s_add_u32 s87, s65, 5
  s_and_b32 s87, s87, 15
  s_lshl_b32 s87, s87, 10
  s_add_u32 s87, s87, s68
  buffer_load_dwordx4 a[20:23], v35, s[12:15], s87 offen sc1
  s_add_u32 s87, s65, 6
  s_and_b32 s87, s87, 15
  s_lshl_b32 s87, s87, 10
  s_add_u32 s87, s87, s68
  buffer_load_dwordx4 a[24:27], v35, s[12:15], s87 offen sc1
  s_add_u32 s87, s65, 7
  s_and_b32 s87, s87, 15
  s_lshl_b32 s87, s87, 10
  s_add_u32 s87, s87, s68
  buffer_load_dwordx4 a[28:31], v35, s[12:15], s87 offen sc1
  buffer_load_dword v23, v23, s[12:15], 0 offen sc1
  s_waitcnt lgkmcnt(0)
  s_waitcnt vmcnt(8)
  v_mfma_f32_16x16x32_bf16 v[120:123], a[32:35], a[0:3], 0
  v_mfma_f32_16x16x32_bf16 v[124:127], a[36:39], a[0:3], 0
  v_mfma_f32_16x16x32_bf16 v[128:131], a[40:43], a[0:3], 0
  v_mfma_f32_16x16x32_bf16 v[132:135], a[44:47], a[0:3], 0
  s_waitcnt vmcnt(7)
  v_mfma_f32_16x16x32_bf16 v[120:123], a[48:51], a[4:7], v[120:123]
  v_mfma_f32_16x16x32_bf16 v[124:127], a[52:55], a[4:7], v[124:127]
  v_mfma_f32_16x16x32_bf16 v[128:131], a[56:59], a[4:7], v[128:131]
  v_mfma_f32_16x16x32_bf16 v[132:135], a[60:63], a[4:7], v[132:135]
  s_waitcnt vmcnt(6)
  v_mfma_f32_16x16x32_bf16 v[120:123], a[64:67], a[8:11], v[120:123]
  v_mfma_f32_16x16x32_bf16 v[124:127], a[68:71], a[8:11], v[124:127]
  v_mfma_f32_16x16x32_bf16 v[128:131], a[72:75], a[8:11], v[128:131]
  v_mfma_f32_16x16x32_bf16 v[132:135], a[76:79], a[8:11], v[132:135]
  s_waitcnt vmcnt(5)
  v_mfma_f32_16x16x32_bf16 v[120:123], a[80:83], a[12:15], v[120:123]
  v_mfma_f32_16x16x32_bf16 v[124:127], a[84:87], a[12:15], v[124:127]
  v_mfma_f32_16x16x32_bf16 v[128:131], a[88:91], a[12:15], v[128:131]
  v_mfma_f32_16x16x32_bf16 v[132:135], a[92:95], a[12:15], v[132:135]
  s_waitcnt vmcnt(4)
  v_mfma_f32_16x16x32_bf16 v[120:123], a[96:99], a[16:19], v[120:123]
  v_mfma_f32_16x16x32_bf16 v[124:127], a[100:103], a[16:19], v[124:127]
  v_mfma_f32_16x16x32_bf16 v[128:131], a[104:107], a[16:19], v[128:131]
  v_mfma_f32_16x16x32_bf16 v[132:135], a[108:111], a[16:19], v[132:135]
  s_waitcnt vmcnt(3)
  v_mfma_f32_16x16x32_bf16 v[120:123], v[56:59], a[20:23], v[120:123]
  v_mfma_f32_16x16x32_bf16 v[124:127], v[60:63], a[20:23], v[124:127]
  v_mfma_f32_16x16x32_bf16 v[128:131], v[64:67], a[20:23], v[128:131]
  v_mfma_f32_16x16x32_bf16 v[132:135], v[68:71], a[20:23], v[132:135]
  s_waitcnt vmcnt(2)
  v_mfma_f32_16x16x32_bf16 v[120:123], v[72:75], a[24:27], v[120:123]
  v_mfma_f32_16x16x32_bf16 v[124:127], v[76:79], a[24:27], v[124:127]
  v_mfma_f32_16x16x32_bf16 v[128:131], v[80:83], a[24:27], v[128:131]
  v_mfma_f32_16x16x32_bf16 v[132:135], v[84:87], a[24:27], v[132:135]
  s_waitcnt vmcnt(1)
  v_mfma_f32_16x16x32_bf16 v[120:123], v[88:91], a[28:31], v[120:123]
  v_mfma_f32_16x16x32_bf16 v[124:127], v[92:95], a[28:31], v[124:127]
  v_mfma_f32_16x16x32_bf16 v[128:131], v[96:99], a[28:31], v[128:131]
  v_mfma_f32_16x16x32_bf16 v[132:135], v[100:103], a[28:31], v[132:135]
  s_lshl_b32 s86, s62, 14
  v_add_u32 v6, s86, v26
  v_xor_b32 v7, 16384, v6
  s_cmp_lg_u32 s62, 0
  s_cbranch_scc1 L_x1
  ds_write_b128 v6, v[112:115] offset:0
  s_nop 0
  ds_write_b128 v6, v[128:131] offset:1024
  ds_write_b128 v6, v[116:119] offset:2048
  ds_write_b128 v6, v[132:135] offset:3072
  s_waitcnt lgkmcnt(0)
  s_barrier
  ds_read_b128 v[72:75], v7 offset:0
  ds_read_b128 v[76:79], v7 offset:1024
  ds_read_b128 v[80:83], v7 offset:2048
  ds_read_b128 v[84:87], v7 offset:3072
  s_waitcnt vmcnt(0)
  s_waitcnt lgkmcnt(2)
  v_add_f32 v104, v104, v72
  v_add_f32 v105, v105, v73
  v_add_f32 v106, v106, v74
  v_add_f32 v107, v107, v75
  v_add_f32 v120, v120, v76
  v_add_f32 v121, v121, v77
  v_add_f32 v122, v122, v78
  v_add_f32 v123, v123, v79
  v_sub_f32 v104, v104, v120
  v_sub_f32 v105, v105, v121
  v_sub_f32 v106, v106, v122
  v_sub_f32 v107, v107, v123
  v_fma_f32 v104, v104, v23, v120
  v_fma_f32 v105, v105, v23, v121
  v_fma_f32 v106, v106, v23, v122
  v_fma_f32 v107, v107, v23, v123
  v_cvt_pk_bf16_f32 v120, v104, v105
  v_cvt_pk_bf16_f32 v121, v106, v107
  v_xor_b32 v2, 0, v24
  ds_write_b64 v2, v[120:121]
  s_waitcnt lgkmcnt(1)
  v_add_f32 v108, v108, v80
  v_add_f32 v109, v109, v81
  v_add_f32 v110, v110, v82
  v_add_f32 v111, v111, v83
  v_add_f32 v124, v124, v84
  v_add_f32 v125, v125, v85
  v_add_f32 v126, v126, v86
  v_add_f32 v127, v127, v87
  v_sub_f32 v108, v108, v124
  v_sub_f32 v109, v109, v125
  v_sub_f32 v110, v110, v126
  v_sub_f32 v111, v111, v127
  v_fma_f32 v108, v108, v23, v124
  v_fma_f32 v109, v109, v23, v125
  v_fma_f32 v110, v110, v23, v126
  v_fma_f32 v111, v111, v23, v127
  v_cvt_pk_bf16_f32 v124, v108, v109
  v_cvt_pk_bf16_f32 v125, v110, v111
  v_xor_b32 v3, 32, v24
  ds_write_b64 v3, v[124:125]
  s_branch L_x2
L_x1:
  ds_write_b128 v6, v[104:107] offset:0
  ds_write_b128 v6, v[120:123] offset:1024
  ds_write_b128 v6, v[108:111] offset:2048
  ds_write_b128 v6, v[124:127] offset:3072
  s_waitcnt lgkmcnt(0)
  s_barrier
  ds_read_b128 v[72:75], v7 offset:0
  ds_read_b128 v[76:79], v7 offset:1024
  ds_read_b128 v[80:83], v7 offset:2048
  ds_read_b128 v[84:87], v7 offset:3072
  s_waitcnt vmcnt(0)
  s_waitcnt lgkmcnt(2)
  v_add_f32 v112, v112, v72
  v_add_f32 v113, v113, v73
  v_add_f32 v114, v114, v74
  v_add_f32 v115, v115, v75
  v_add_f32 v128, v128, v76
  v_add_f32 v129, v129, v77
  v_add_f32 v130, v130, v78
  v_add_f32 v131, v131, v79
  v_sub_f32 v112, v112, v128
  v_sub_f32 v113, v113, v129
  v_sub_f32 v114, v114, v130
  v_sub_f32 v115, v115, v131
  v_fma_f32 v112, v112, v23, v128
  v_fma_f32 v113, v113, v23, v129
  v_fma_f32 v114, v114, v23, v130
  v_fma_f32 v115, v115, v23, v131
  v_cvt_pk_bf16_f32 v128, v112, v113
  v_cvt_pk_bf16_f32 v129, v114, v115
  v_xor_b32 v2, 64, v24
  ds_write_b64 v2, v[128:129]
  s_waitcnt lgkmcnt(1)
  v_add_f32 v116, v116, v80
  v_add_f32 v117, v117, v81
  v_add_f32 v118, v118, v82
  v_add_f32 v119, v119, v83
  v_add_f32 v132, v132, v84
  v_add_f32 v133, v133, v85
  v_add_f32 v134, v134, v86
  v_add_f32 v135, v135, v87
  v_sub_f32 v116, v116, v132
  v_sub_f32 v117, v117, v133
  v_sub_f32 v118, v118, v134
  v_sub_f32 v119, v119, v135
  v_fma_f32 v116, v116, v23, v132
  v_fma_f32 v117, v117, v23, v133
  v_fma_f32 v118, v118, v23, v134
  v_fma_f32 v119, v119, v23, v135
  v_cvt_pk_bf16_f32 v132, v116, v117
  v_cvt_pk_bf16_f32 v133, v118, v119
  v_xor_b32 v3, 96, v24
  ds_write_b64 v3, v[132:133]
L_x2:
  s_waitcnt lgkmcnt(0)
  s_barrier
  s_lshl_b32 s86, s62, 10
  v_add_u32 v25, s86, v25
  ds_read_b128 v[40:43], v25
  s_mul_i32 s86, s62, 14336
  s_waitcnt lgkmcnt(0)
  buffer_store_dwordx4 v[40:43], v22, s[24:27], s86 offen
L_fin:
L_end:
  s_endpgm
.section .rodata,"a"
.p2align 6
.amdhsa_kernel gated_mix__sliding_local_dilated__linear_attn_block__prompt_kernel
  .amdhsa_next_free_vgpr 256
  .amdhsa_next_free_sgpr 102
  .amdhsa_accum_offset 136
  .amdhsa_group_segment_fixed_size 0
  .amdhsa_kernarg_size 80
  .amdhsa_user_sgpr_count 2
  .amdhsa_user_sgpr_kernarg_segment_ptr 1
  .amdhsa_system_sgpr_workgroup_id_x 1
.end_amdhsa_kernel
```
